```python
import torch

def _softmax(x, axis=-1):
    return torch.softmax(x, dim=axis)
def _gelu(x):
    return torch.nn.functional.gelu(x, approximate="tanh")
def _silu(x):
    return torch.nn.functional.silu(x)
def _sigmoid(x):
    return torch.sigmoid(x)
def _layernorm(x, axis=-1, eps=1e-5):
    m = x.mean(dim=axis, keepdim=True)
    v = x.var(dim=axis, keepdim=True, unbiased=False)
    return (x - m) / torch.sqrt(v + eps)
def _scatter_add(tgt, idx, src, axis=0):
    return tgt.clone().index_add_(axis, idx, src)
def _segment_sum(src, seg, n):
    out = torch.zeros((n,) + src.shape[1:], dtype=src.dtype)
    return out.index_add_(0, seg, src)
def _pad(x, pw):
    flat = tuple(v for pair in reversed(pw) for v in pair)
    return torch.nn.functional.pad(x, flat)

kernel_name = 'parallel_sum__mha_block_cached__glu_gated_glu__decode'

def setup_inputs():

    _w = (lambda a: (lambda t: t.to(torch.bfloat16) if t.is_floating_point() else t)(torch.as_tensor(a)))
    def _A_setup():
        B, Sq, D = 1, 1, 640
        H, Sk, Dh = 32, 4096, 192
        return {
            "x": _w((lambda *s: torch.randn(*s, dtype=torch.bfloat16) * 0.05)(B, Sq, D)),
            "k_cache": _w((lambda *s: torch.randn(*s, dtype=torch.bfloat16) * 3.2)(B, H, Sk, Dh)),
            "v_cache": _w((lambda *s: torch.randn(*s, dtype=torch.bfloat16) * 1.6)(B, H, Sk, Dh)),
            "wq": _w((lambda *s: torch.randn(*s, dtype=torch.bfloat16) * 3.2)(D, H * Dh) * (D ** -0.5)),
            "wo": _w((lambda *s: torch.randn(*s, dtype=torch.bfloat16) * 1.6)(H * Dh, D) * ((H * Dh) ** -0.5)),
        }
    _A_in = _A_setup()

    def _B_setup():
        B, S, D, F = 1, 1, 640, 1536
        return {
            "x": _w((lambda *s: torch.randn(*s, dtype=torch.bfloat16) * 0.05)(B, S, D)),
            "w_gate": _w((lambda *s: torch.randn(*s, dtype=torch.bfloat16) * 1.6)(D, F)),
            "w_up": _w((lambda *s: torch.randn(*s, dtype=torch.bfloat16) * 0.1)(D, F)),
            "w_down": _w((lambda *s: torch.randn(*s, dtype=torch.bfloat16) * 0.1)(F, D)),
        }
    _B_in = _B_setup()

    return {
        "A_x": _A_in["x"],
        "A_k_cache": _A_in["k_cache"],
        "A_v_cache": _A_in["v_cache"],
        "A_wq": _A_in["wq"],
        "A_wo": _A_in["wo"],
        "B_x": _B_in["x"],
        "B_w_gate": _B_in["w_gate"],
        "B_w_up": _B_in["w_up"],
        "B_w_down": _B_in["w_down"],
    }

def reference(A_x, A_k_cache, A_v_cache, A_wq, A_wo, B_x, B_w_gate, B_w_up, B_w_down):
    def _A_ref(x, k_cache, v_cache, wq, wo):
        B, Sq, D = x.shape
        H, Dh = 32, 192
        q = (lambda x, *d: x.permute(*d))((x @ wq).reshape(B, Sq, H, Dh), 0, 2, 1, 3)
        scores = torch.einsum("bhqd,bhkd->bhqk", q, k_cache) * (Dh ** -0.5)
        p = _softmax(scores, axis=-1)
        o = torch.einsum("bhqk,bhkd->bhqd", p, v_cache)
        return (lambda x, *d: x.permute(*d))(o, 0, 2, 1, 3).reshape(B, Sq, H * Dh) @ wo

    def _B_ref(x, w_gate, w_up, w_down):
        g = torch.einsum("bsd,df->bsf", x, w_gate)
        u = torch.einsum("bsd,df->bsf", x, w_up)
        h = _sigmoid(g) * u
        return torch.einsum("bsf,fd->bsd", h, w_down)

    x = A_x
    xn = _layernorm(x, axis=-1)
    return x + _A_ref(xn, A_k_cache, A_v_cache, A_wq, A_wo) + _B_ref(xn, B_w_gate, B_w_up, B_w_down)
```

```asm
; @launch grid=(256,1,1) block=(832,1,1) lds=11136
.amdgcn_target "amdgcn-amd-amdhsa--gfx950"
.text
.globl parallel_sum__mha_block_cached__glu_gated_glu__decode_kernel
.p2align 8
.type parallel_sum__mha_block_cached__glu_gated_glu__decode_kernel,@function
parallel_sum__mha_block_cached__glu_gated_glu__decode_kernel:
    s_cmp_ge_u32 s2, 256
    s_cbranch_scc1 .Lend
    s_load_dwordx16 s[64:79], s[0:1], 0
    s_load_dwordx8 s[80:87], s[0:1], 64
    v_lshrrev_b32 v1, 6, v0
    v_and_b32 v0, 63, v0
    v_readfirstlane_b32 s3, v1
    s_and_b32 s24, s2, 7
    s_lshl_b32 s24, s24, 2
    s_bfe_u32 s25, s2, 0x20003
    s_or_b32 s24, s24, s25
    s_lshr_b32 s25, s2, 5
    v_lshrrev_b32 v4, 3, v0
    v_and_b32 v5, 7, v0
    s_cmp_lt_u32 s3, 5
    s_cbranch_scc1 .Laux

    v_mul_u32_u24 v1, 384, v4
    v_lshl_add_u32 v1, v5, 4, v1
    s_sub_u32 s48, s3, 5
    s_mul_i32 s28, s24, 1572864
    s_mul_i32 s29, s25, 196608
    s_add_u32 s28, s28, s29
    s_mul_i32 s29, s48, 24576
    s_add_u32 s28, s28, s29
    s_add_u32 s29, s28, 6144
    s_add_u32 s30, s28, 12288
    s_add_u32 s31, s28, 18432

    s_waitcnt lgkmcnt(0)
    s_mov_b32 s4, s66
    s_mov_b32 s5, s67
    s_mov_b32 s6, 50331648
    s_mov_b32 s7, 0x00020000
    buffer_load_dwordx4 v[32:35], v1, s[4:7], s28 offen offset:0 nt
    buffer_load_dwordx4 v[36:39], v1, s[4:7], s28 offen offset:128 nt
    buffer_load_dwordx4 v[40:43], v1, s[4:7], s28 offen offset:256 nt
    s_load_dword s26, s[86:87], 0
    s_mov_b32 s8, s68
    s_mov_b32 s9, s69
    s_mov_b32 s10, 50331648
    s_mov_b32 s11, 0x00020000
    s_mov_b32 s12, s86
    s_mov_b32 s13, s87
    s_mov_b32 s14, 268435456
    s_mov_b32 s15, 0x00020000
    s_mov_b32 s16, s64
    s_mov_b32 s17, s65
    s_mov_b32 s18, 1280
    s_mov_b32 s19, 0x00020000
    s_mov_b32 s20, s82
    s_mov_b32 s21, s83
    s_mov_b32 s22, 1280
    s_mov_b32 s23, 0x00020000
    s_mov_b32 s32, 0x03030303
    s_mov_b32 s33, 0x03030303
    s_mov_b32 s34, 0x0c0c0c0c
    s_mov_b32 s35, 0x0c0c0c0c
    s_mov_b32 s36, 0x30303030
    s_mov_b32 s37, 0x30303030
    s_mov_b32 s38, 0xc0c0c0c0
    s_mov_b32 s39, 0xc0c0c0c0
    v_and_b32 v2, 1, v0
    v_lshlrev_b32 v2, 4, v2
    v_mov_b32 v3, 0xffff
    v_lshlrev_b32 v2, v2, v3
    v_lshlrev_b32 v6, 4, v5
    s_cmp_eq_u32 s3, 5
    s_cbranch_scc1 .Lpad_0
    s_cmp_eq_u32 s3, 6
    s_cbranch_scc1 .Lpad_1
    s_cmp_eq_u32 s3, 7
    s_cbranch_scc1 .Lpad_2
    s_cmp_eq_u32 s3, 8
    s_cbranch_scc1 .Lpad_3
    s_cmp_eq_u32 s3, 9
    s_cbranch_scc1 .Lpad_4
    s_cmp_eq_u32 s3, 10
    s_cbranch_scc1 .Lpad_5
    s_cmp_eq_u32 s3, 11
    s_cbranch_scc1 .Lpad_6
    s_cmp_eq_u32 s3, 12
    s_cbranch_scc1 .Lpad_7
    s_branch .Lbulk2
.Laux:
    s_setprio 3
    v_mov_b32 v124, 0
    v_mov_b32 v125, 0
    v_mov_b32 v126, 0
    v_mov_b32 v127, 1
    v_lshlrev_b32 v1, 2, v0
    v_and_b32 v3, 60, v1
    ds_write_b32 v3, v124 offset:448
    ds_write_b32 v3, v124 offset:10496
    s_cmp_lt_u32 s3, 3
    s_cbranch_scc1 .Laux_q
    s_and_b32 s52, s24, 3
    s_lshl_b32 s52, s52, 1
    s_sub_u32 s53, s3, 3
    s_add_u32 s52, s52, s53
    s_mul_i32 s48, s52, 80
    s_lshr_b32 s53, s24, 2
    s_mul_i32 s53, s53, 3
    s_add_u32 s53, s53, s25
    s_sub_u32 s54, s53, 3
    s_cmp_ge_u32 s25, 3
    s_cselect_b32 s53, s54, s53
    s_cselect_b32 s54, 98304, 0
    s_lshl_b32 s49, s53, 7
    s_movk_i32 s50, 3072
    s_mul_i32 s51, s52, 12288
    s_lshl_b32 s53, s53, 9
    s_add_u32 s51, s51, s53
    s_mov_b32 s53, s54
    s_add_u32 s51, s51, s54
    s_add_u32 s51, s51, 524288
    s_add_u32 s6, s48, 80
    s_waitcnt lgkmcnt(0)
    s_cmp_eq_u32 s53, 0
    s_cselect_b32 s4, s76, s78
    s_cselect_b32 s5, s77, s79
    s_branch .Laux_p
.Laux_q:
    s_mul_i32 s48, s25, 88
    s_add_u32 s6, s48, 88
    s_mul_i32 s52, s25, 56
    s_add_u32 s52, s52, 192
    s_add_u32 s53, s52, 56
    s_cmp_ge_u32 s25, 6
    s_cselect_b32 s48, s52, s48
    s_cselect_b32 s6, s53, s6
    s_mul_i32 s49, s24, 384
    s_lshl_b32 s53, s3, 7
    s_add_u32 s49, s49, s53
    s_movk_i32 s50, 12288
    s_mul_i32 s51, s24, 12288
    s_mul_i32 s52, s25, 1536
    s_add_u32 s51, s51, s52
    s_lshl_b32 s53, s3, 9
    s_add_u32 s51, s51, s53
    s_add_u32 s51, s51, 65536
    s_waitcnt lgkmcnt(0)
    s_mov_b32 s4, s70
    s_mov_b32 s5, s71
.Laux_p:
    s_mul_i32 s6, s6, s50
    s_mov_b32 s7, 0x00020000

    s_mov_b32 s16, s64
    s_mov_b32 s17, s65
    s_mov_b32 s18, 1280
    s_mov_b32 s19, 0x00020000
    s_cmp_lt_u32 s3, 3
    s_cbranch_scc1 .Laux_s1
    s_cmp_ge_u32 s25, 6
    s_cbranch_scc1 .Laux_s1skip
.Laux_s1:
    buffer_load_dword v8, v1, s[16:19], 0 offen offset:0
    buffer_load_dword v9, v1, s[16:19], 0 offen offset:256
    buffer_load_dword v10, v1, s[16:19], 0 offen offset:512
    buffer_load_dword v11, v1, s[16:19], 0 offen offset:768
    buffer_load_dword v12, v1, s[16:19], 0 offen offset:1024
    v_mul_lo_u32 v6, v4, s50
    v_lshl_add_u32 v6, v5, 4, v6
    s_mul_i32 s52, s48, s50
    s_add_u32 s52, s52, s49
    s_lshl_b32 s50, s50, 3
    buffer_load_dwordx4 v[32:35], v6, s[4:7], s52 offen nt
    s_add_u32 s52, s52, s50
    buffer_load_dwordx4 v[36:39], v6, s[4:7], s52 offen nt
    s_add_u32 s52, s52, s50
    buffer_load_dwordx4 v[40:43], v6, s[4:7], s52 offen nt
    s_add_u32 s52, s52, s50
    buffer_load_dwordx4 v[44:47], v6, s[4:7], s52 offen nt
    s_add_u32 s52, s52, s50
    buffer_load_dwordx4 v[48:51], v6, s[4:7], s52 offen nt
    s_add_u32 s52, s52, s50
    buffer_load_dwordx4 v[52:55], v6, s[4:7], s52 offen nt
    s_add_u32 s52, s52, s50
    buffer_load_dwordx4 v[56:59], v6, s[4:7], s52 offen nt
    s_add_u32 s52, s52, s50
    buffer_load_dwordx4 v[60:63], v6, s[4:7], s52 offen nt
    s_add_u32 s52, s52, s50
    buffer_load_dwordx4 v[64:67], v6, s[4:7], s52 offen nt
    s_add_u32 s52, s52, s50
    buffer_load_dwordx4 v[68:71], v6, s[4:7], s52 offen nt
    s_add_u32 s52, s52, s50
    buffer_load_dwordx4 v[72:75], v6, s[4:7], s52 offen nt
.Laux_s1skip:
.Laux2:
    s_barrier
    s_load_dword s26, s[86:87], 0
    s_mov_b32 s8, s72
    s_mov_b32 s9, s73
    s_mov_b32 s10, 7864320
    s_mov_b32 s11, 0x00020000
    s_mov_b32 s12, s86
    s_mov_b32 s13, s87
    s_mov_b32 s14, 268435456
    s_mov_b32 s15, 0x00020000
    s_mov_b32 s20, s80
    s_mov_b32 s21, s81
    s_mov_b32 s22, 1966080
    s_mov_b32 s23, 0x00020000
    s_mov_b32 s32, 0x03030303
    s_mov_b32 s33, 0x03030303
    s_mov_b32 s34, 0x0c0c0c0c
    s_mov_b32 s35, 0x0c0c0c0c
    s_mov_b32 s36, 0x30303030
    s_mov_b32 s37, 0x30303030
    s_mov_b32 s38, 0xc0c0c0c0
    s_mov_b32 s39, 0xc0c0c0c0
    v_and_b32 v2, 1, v0
    v_lshlrev_b32 v2, 4, v2
    s_lshl_b32 s55, s24, 1
    s_add_u32 s55, s55, s25
    s_sub_u32 s55, s55, 6
    s_cmp_lt_u32 s3, 3
    s_cbranch_scc1 .Laux_ln
    s_cmp_ge_u32 s25, 6
    s_cbranch_scc1 .Laux_pub_skip
.Laux_ln:
    s_waitcnt vmcnt(11)
    v_lshlrev_b32 v100, 16, v8
    v_and_b32 v101, 0xffff0000, v8
    v_lshlrev_b32 v102, 16, v9
    v_and_b32 v103, 0xffff0000, v9
    v_lshlrev_b32 v104, 16, v10
    v_and_b32 v105, 0xffff0000, v10
    v_lshlrev_b32 v106, 16, v11
    v_and_b32 v107, 0xffff0000, v11
    v_lshlrev_b32 v108, 16, v12
    v_and_b32 v109, 0xffff0000, v12
    v_add_f32 v13, v100, v101
    v_add_f32 v13, v13, v102
    v_add_f32 v13, v13, v103
    v_add_f32 v13, v13, v104
    v_add_f32 v13, v13, v105
    v_add_f32 v13, v13, v106
    s_branch .Lskip_0
.Lpad_0:
    s_branch .Lbulk2
.Lskip_0:
    v_add_f32 v13, v13, v107
    v_add_f32 v13, v13, v108
    v_add_f32 v13, v13, v109
    s_nop 1
    v_add_f32_dpp v13, v13, v13 quad_perm:[1,0,3,2] row_mask:0xf bank_mask:0xf
    s_nop 1
    v_add_f32_dpp v13, v13, v13 quad_perm:[2,3,0,1] row_mask:0xf bank_mask:0xf
    s_nop 1
    v_add_f32_dpp v13, v13, v13 row_half_mirror row_mask:0xf bank_mask:0xf
    s_nop 1
    v_add_f32_dpp v13, v13, v13 row_ror:8 row_mask:0xf bank_mask:0xf
    v_mov_b32 v14, v13
    s_nop 1
    v_permlane16_swap_b32 v13, v14
    v_add_f32 v13, v13, v14
    v_mov_b32 v14, v13
    s_nop 1
    v_permlane32_swap_b32 v13, v14
    v_add_f32 v13, v13, v14
    v_mul_f32 v13, 0x3acccccd, v13
    v_sub_f32 v15, v100, v13
    v_mul_f32 v14, v15, v15
    v_sub_f32 v15, v101, v13
    v_fma_f32 v14, v15, v15, v14
    v_sub_f32 v15, v102, v13
    v_fma_f32 v14, v15, v15, v14
    v_sub_f32 v15, v103, v13
    v_fma_f32 v14, v15, v15, v14
    v_sub_f32 v15, v104, v13
    v_fma_f32 v14, v15, v15, v14
    v_sub_f32 v15, v105, v13
    v_fma_f32 v14, v15, v15, v14
    v_sub_f32 v15, v106, v13
    v_fma_f32 v14, v15, v15, v14
    v_sub_f32 v15, v107, v13
    v_fma_f32 v14, v15, v15, v14
    v_sub_f32 v15, v108, v13
    v_fma_f32 v14, v15, v15, v14
    v_sub_f32 v15, v109, v13
    v_fma_f32 v14, v15, v15, v14
    s_nop 1
    v_add_f32_dpp v14, v14, v14 quad_perm:[1,0,3,2] row_mask:0xf bank_mask:0xf
    s_nop 1
    v_add_f32_dpp v14, v14, v14 quad_perm:[2,3,0,1] row_mask:0xf bank_mask:0xf
    s_nop 1
    v_add_f32_dpp v14, v14, v14 row_half_mirror row_mask:0xf bank_mask:0xf
    s_nop 1
    v_add_f32_dpp v14, v14, v14 row_ror:8 row_mask:0xf bank_mask:0xf
    v_mov_b32 v15, v14
    s_nop 1
    v_permlane16_swap_b32 v14, v15
    v_add_f32 v14, v14, v15
    v_mov_b32 v15, v14
    s_nop 1
    v_permlane32_swap_b32 v14, v15
    v_add_f32 v14, v14, v15
    v_mul_f32 v14, 0x3acccccd, v14
    v_cvt_pk_bf16_f32 v14, v14, v14
    v_lshlrev_b32 v14, 16, v14
    v_add_f32 v14, 0x3727c5ac, v14
    v_cvt_pk_bf16_f32 v14, v14, v14
    v_lshlrev_b32 v14, 16, v14
    v_sqrt_f32 v14, v14
    s_nop 0
    v_cvt_pk_bf16_f32 v14, v14, v14
    v_lshlrev_b32 v14, 16, v14
    v_rcp_f32 v14, v14
    v_cvt_pk_bf16_f32 v13, v13, v13
    v_lshlrev_b32 v13, 16, v13
    v_sub_f32 v100, v100, v13
    v_sub_f32 v101, v101, v13
    v_sub_f32 v102, v102, v13
    v_sub_f32 v103, v103, v13
    v_sub_f32 v104, v104, v13
    v_sub_f32 v105, v105, v13
    v_sub_f32 v106, v106, v13
    v_sub_f32 v107, v107, v13
    v_sub_f32 v108, v108, v13
    v_sub_f32 v109, v109, v13
    v_cvt_pk_bf16_f32 v8, v100, v101
    v_lshlrev_b32 v100, 16, v8
    v_and_b32 v101, 0xffff0000, v8
    v_mul_f32 v100, v100, v14
    v_mul_f32 v101, v101, v14
    v_cvt_pk_bf16_f32 v8, v100, v101
    ds_write_b32 v1, v8 offset:9216
    v_cvt_pk_bf16_f32 v9, v102, v103
    v_lshlrev_b32 v102, 16, v9
    v_and_b32 v103, 0xffff0000, v9
    v_mul_f32 v102, v102, v14
    v_mul_f32 v103, v103, v14
    v_cvt_pk_bf16_f32 v9, v102, v103
    ds_write_b32 v1, v9 offset:9472
    v_cvt_pk_bf16_f32 v10, v104, v105
    v_lshlrev_b32 v104, 16, v10
    v_and_b32 v105, 0xffff0000, v10
    v_mul_f32 v104, v104, v14
    v_mul_f32 v105, v105, v14
    v_cvt_pk_bf16_f32 v10, v104, v105
    ds_write_b32 v1, v10 offset:9728
    v_cvt_pk_bf16_f32 v11, v106, v107
    v_lshlrev_b32 v106, 16, v11
    v_and_b32 v107, 0xffff0000, v11
    v_mul_f32 v106, v106, v14
    v_mul_f32 v107, v107, v14
    v_cvt_pk_bf16_f32 v11, v106, v107
    ds_write_b32 v1, v11 offset:9984
    v_cvt_pk_bf16_f32 v12, v108, v109
    v_lshlrev_b32 v108, 16, v12
    v_and_b32 v109, 0xffff0000, v12
    v_mul_f32 v108, v108, v14
    v_mul_f32 v109, v109, v14
    v_cvt_pk_bf16_f32 v12, v108, v109
    ds_write_b32 v1, v12 offset:10240
    v_add_lshl_u32 v3, v4, s48, 1
    ds_read_u16 v13, v3 offset:9216
    ds_read_u16 v14, v3 offset:9232
    ds_read_u16 v15, v3 offset:9248
    ds_read_u16 v16, v3 offset:9264
    ds_read_u16 v17, v3 offset:9280
    ds_read_u16 v18, v3 offset:9296
    ds_read_u16 v19, v3 offset:9312
    ds_read_u16 v20, v3 offset:9328
    ds_read_u16 v21, v3 offset:9344
    ds_read_u16 v22, v3 offset:9360
    ds_read_u16 v23, v3 offset:9376
    s_waitcnt lgkmcnt(0)
    s_mul_i32 s26, s26, 0x19660d
    s_add_u32 s26, s26, 0x3c6ef35f
    v_lshlrev_b32 v13, v2, v13
    v_cndmask_b32 v24, 0, v13, s[32:33]
    v_cndmask_b32 v25, 0, v13, s[34:35]
    v_cndmask_b32 v26, 0, v13, s[36:37]
    v_cndmask_b32 v27, 0, v13, s[38:39]
    s_waitcnt vmcnt(10)
    s_nop 0
    v_mfma_f32_16x16x32_bf16 v[116:119], v[24:27], v[32:35], 0
    v_lshlrev_b32 v14, v2, v14
    v_cndmask_b32 v28, 0, v14, s[32:33]
    v_cndmask_b32 v29, 0, v14, s[34:35]
    v_cndmask_b32 v30, 0, v14, s[36:37]
    v_cndmask_b32 v31, 0, v14, s[38:39]
    s_waitcnt vmcnt(9)
    s_nop 0
    v_mfma_f32_16x16x32_bf16 v[116:119], v[28:31], v[36:39], v[116:119]
    v_lshlrev_b32 v15, v2, v15
    v_cndmask_b32 v24, 0, v15, s[32:33]
    v_cndmask_b32 v25, 0, v15, s[34:35]
    v_cndmask_b32 v26, 0, v15, s[36:37]
    v_cndmask_b32 v27, 0, v15, s[38:39]
    s_waitcnt vmcnt(8)
    s_nop 0
    v_mfma_f32_16x16x32_bf16 v[116:119], v[24:27], v[40:43], v[116:119]
    v_lshlrev_b32 v16, v2, v16
    v_cndmask_b32 v28, 0, v16, s[32:33]
    v_cndmask_b32 v29, 0, v16, s[34:35]
    v_cndmask_b32 v30, 0, v16, s[36:37]
    v_cndmask_b32 v31, 0, v16, s[38:39]
    s_waitcnt vmcnt(7)
    s_nop 0
    v_mfma_f32_16x16x32_bf16 v[116:119], v[28:31], v[44:47], v[116:119]
    v_lshlrev_b32 v17, v2, v17
    v_cndmask_b32 v24, 0, v17, s[32:33]
    v_cndmask_b32 v25, 0, v17, s[34:35]
    v_cndmask_b32 v26, 0, v17, s[36:37]
    v_cndmask_b32 v27, 0, v17, s[38:39]
    s_waitcnt vmcnt(6)
    s_nop 0
    v_mfma_f32_16x16x32_bf16 v[116:119], v[24:27], v[48:51], v[116:119]
    v_lshlrev_b32 v18, v2, v18
    v_cndmask_b32 v28, 0, v18, s[32:33]
    v_cndmask_b32 v29, 0, v18, s[34:35]
    v_cndmask_b32 v30, 0, v18, s[36:37]
    v_cndmask_b32 v31, 0, v18, s[38:39]
    s_waitcnt vmcnt(5)
    s_nop 0
    v_mfma_f32_16x16x32_bf16 v[116:119], v[28:31], v[52:55], v[116:119]
    v_lshlrev_b32 v19, v2, v19
    v_cndmask_b32 v24, 0, v19, s[32:33]
    v_cndmask_b32 v25, 0, v19, s[34:35]
    v_cndmask_b32 v26, 0, v19, s[36:37]
    v_cndmask_b32 v27, 0, v19, s[38:39]
    s_waitcnt vmcnt(4)
    s_nop 0
    v_mfma_f32_16x16x32_bf16 v[116:119], v[24:27], v[56:59], v[116:119]
    v_lshlrev_b32 v20, v2, v20
    v_cndmask_b32 v28, 0, v20, s[32:33]
    v_cndmask_b32 v29, 0, v20, s[34:35]
    v_cndmask_b32 v30, 0, v20, s[36:37]
    v_cndmask_b32 v31, 0, v20, s[38:39]
    s_waitcnt vmcnt(3)
    s_nop 0
    v_mfma_f32_16x16x32_bf16 v[116:119], v[28:31], v[60:63], v[116:119]
    v_lshlrev_b32 v21, v2, v21
    v_cndmask_b32 v24, 0, v21, s[32:33]
    v_cndmask_b32 v25, 0, v21, s[34:35]
    v_cndmask_b32 v26, 0, v21, s[36:37]
    v_cndmask_b32 v27, 0, v21, s[38:39]
    s_waitcnt vmcnt(2)
    s_nop 0
    v_mfma_f32_16x16x32_bf16 v[116:119], v[24:27], v[64:67], v[116:119]
    v_lshlrev_b32 v22, v2, v22
    v_cndmask_b32 v28, 0, v22, s[32:33]
    v_cndmask_b32 v29, 0, v22, s[34:35]
    v_cndmask_b32 v30, 0, v22, s[36:37]
    v_cndmask_b32 v31, 0, v22, s[38:39]
    s_waitcnt vmcnt(1)
    s_nop 0
    v_mfma_f32_16x16x32_bf16 v[116:119], v[28:31], v[68:71], v[116:119]
    v_lshlrev_b32 v23, v2, v23
    s_branch .Lskip_1
.Lpad_1:
    s_branch .Lbulk2
.Lskip_1:
    v_cndmask_b32 v24, 0, v23, s[32:33]
    v_cndmask_b32 v25, 0, v23, s[34:35]
    v_cndmask_b32 v26, 0, v23, s[36:37]
    v_cndmask_b32 v27, 0, v23, s[38:39]
    s_waitcnt vmcnt(0)
    s_nop 0
    v_mfma_f32_16x16x32_bf16 v[116:119], v[24:27], v[72:75], v[116:119]
    v_lshlrev_b32 v1, 4, v0
    s_nop 6
    v_permlane32_swap_b32 v116, v117
    v_permlane32_swap_b32 v118, v119
    s_nop 0
    v_add_f32_dpp v36, v117, v116 row_ror:8 row_mask:0xf bank_mask:0x3
    s_nop 1
    v_add_f32_dpp v36, v118, v119 row_ror:8 row_mask:0xf bank_mask:0xc
    v_mov_b32 v37, s26
    v_mov_b32 v39, s26
    v_permlane32_swap_b32 v36, v38
    s_mov_b32 exec_hi, 0
    buffer_store_dwordx4 v[36:39], v1, s[12:15], s51 offen
    s_mov_b64 exec, -1
    s_branch .Laux_pub_done
.Laux_pub_skip:
    s_waitcnt lgkmcnt(0)
    s_mul_i32 s26, s26, 0x19660d
    s_add_u32 s26, s26, 0x3c6ef35f
.Laux_pub_done:
    s_cmp_lt_u32 s25, 6
    s_cbranch_scc1 .Laux_nowdl
    s_mul_i32 s56, s55, 24
    v_add_u32 v3, s56, v4
    v_and_b32 v16, 0xffffffc1, v3
    v_bfe_u32 v6, v3, 1, 3
    v_lshl_or_b32 v16, v6, 3, v16
    v_bfe_u32 v6, v3, 4, 2
    v_lshl_or_b32 v16, v6, 1, v16
    v_mul_u32_u24 v16, 1280, v16
    v_lshl_add_u32 v16, v5, 4, v16
    s_add_u32 s56, s56, 8
    v_add_u32 v3, s56, v4
    v_and_b32 v17, 0xffffffc1, v3
    v_bfe_u32 v6, v3, 1, 3
    v_lshl_or_b32 v17, v6, 3, v17
    v_bfe_u32 v6, v3, 4, 2
    v_lshl_or_b32 v17, v6, 1, v17
    v_mul_u32_u24 v17, 1280, v17
    v_lshl_add_u32 v17, v5, 4, v17
    s_add_u32 s56, s56, 8
    v_add_u32 v3, s56, v4
    v_and_b32 v18, 0xffffffc1, v3
    v_bfe_u32 v6, v3, 1, 3
    v_lshl_or_b32 v18, v6, 3, v18
    v_bfe_u32 v6, v3, 4, 2
    v_lshl_or_b32 v18, v6, 1, v18
    v_mul_u32_u24 v18, 1280, v18
    v_lshl_add_u32 v18, v5, 4, v18
    s_lshl_b32 s52, s3, 8
    buffer_load_dwordx4 v[76:79], v16, s[20:23], s52 offen offset:0 nt
    buffer_load_dwordx4 v[80:83], v16, s[20:23], s52 offen offset:128 nt
    buffer_load_dwordx4 v[84:87], v17, s[20:23], s52 offen offset:0 nt
    buffer_load_dwordx4 v[88:91], v17, s[20:23], s52 offen offset:128 nt
    buffer_load_dwordx4 v[92:95], v18, s[20:23], s52 offen offset:0 nt
    buffer_load_dwordx4 v[96:99], v18, s[20:23], s52 offen offset:128 nt
.Laux_nowdl:
    v_lshrrev_b32 v3, 2, v0
    v_and_b32 v6, 3, v0
    v_lshlrev_b32 v6, 4, v6
    v_lshl_add_u32 v19, v3, 12, v6
    v_lshl_add_u32 v20, v3, 14, v6
    v_lshlrev_b32 v12, 1, v4
    v_mul_u32_u24 v20, 17664, v3
    v_add_u32 v20, v20, v6
    v_mul_u32_u24 v19, 5376, v3
    v_add_u32 v19, v19, v6
    v_and_b32 v13, 15, v0
    v_lshrrev_b32 v14, 4, v0
    s_cmp_ge_u32 s3, 3
    s_cbranch_scc1 .Laux_qdone
    v_and_b32 v1, 31, v0
    v_lshlrev_b32 v1, 4, v1
    v_lshrrev_b32 v3, 5, v0
    v_mul_u32_u24 v3, 1536, v3
    v_add_u32 v1, v1, v3
    s_mul_i32 s52, s24, 12288
    s_lshl_b32 s53, s3, 9
    s_add_u32 s52, s52, s53
    s_add_u32 s52, s52, 65536
    s_add_u32 s53, s52, 6144
    v_lshlrev_b32 v6, 4, v5
    v_bfe_u32 v3, v0, 4, 1
    v_lshl_add_u32 v6, v3, 3, v6
    v_bfe_u32 v3, v0, 3, 1
    v_lshl_add_u32 v6, v3, 2, v6
    s_lshl_b32 s54, s3, 7
    v_add_u32 v6, s54, v6
    s_mov_b32 s27, 320000
.lw_5:
    ds_read_b32 v3, v124 offset:448
    s_waitcnt lgkmcnt(0)
    v_readfirstlane_b32 s40, v3
    s_cmp_ge_u32 s40, 12
    s_cbranch_scc1 .lwd_6
    s_sub_u32 s27, s27, 1
    s_cbranch_scc0 .lw_5
.lwd_6:
    s_mov_b32 s27, 10000
    s_mov_b32 s62, 23
.poll_7:
    buffer_load_dwordx4 v[100:103], v1, s[12:15], s52 offen offset:0 sc1
    buffer_load_dwordx4 v[104:107], v1, s[12:15], s52 offen offset:3072 sc1
    buffer_load_dwordx4 v[108:111], v1, s[12:15], s53 offen offset:0 sc1
    buffer_load_dwordx4 v[112:115], v1, s[12:15], s53 offen offset:3072 sc1
    s_waitcnt vmcnt(0)
    v_cmp_ne_u32 s[40:41], s26, v101
    v_cmp_ne_u32 s[42:43], s26, v103
    s_or_b64 s[40:41], s[40:41], s[42:43]
    v_cmp_ne_u32 s[42:43], s26, v105
    s_or_b64 s[40:41], s[40:41], s[42:43]
    v_cmp_ne_u32 s[42:43], s26, v107
    s_or_b64 s[40:41], s[40:41], s[42:43]
    v_cmp_ne_u32 s[42:43], s26, v109
    s_or_b64 s[40:41], s[40:41], s[42:43]
    v_cmp_ne_u32 s[42:43], s26, v111
    s_or_b64 s[40:41], s[40:41], s[42:43]
    v_cmp_ne_u32 s[42:43], s26, v113
    s_or_b64 s[40:41], s[40:41], s[42:43]
    v_cmp_ne_u32 s[42:43], s26, v115
    s_or_b64 s[40:41], s[40:41], s[42:43]
    s_cmp_eq_u64 s[40:41], 0
    s_cbranch_scc1 .polld_8
    s_sub_u32 s62, s62, 1
    s_cbranch_scc0 .poll_7
    s_mov_b32 s62, 2
    buffer_wbl2 sc1
    s_waitcnt vmcnt(0)
    s_sub_u32 s27, s27, 1
    s_cbranch_scc0 .poll_7
.polld_8:
    v_add_f32 v100, v100, v104
    v_add_f32 v108, v108, v112
    v_add_f32 v102, v102, v106
    v_add_f32 v110, v110, v114
    v_add_f32 v100, v100, v108
    v_add_f32 v102, v102, v110
    v_mov_b32 v101, v100
    v_mov_b32 v103, v102
    s_nop 0
    v_permlane32_swap_b32 v100, v101
    v_permlane32_swap_b32 v102, v103
    v_add_f32 v100, v100, v101
    v_add_f32 v102, v102, v103
    v_cvt_pk_bf16_f32 v100, v100, v102
    ds_write_b32 v6, v100 offset:0
    s_waitcnt lgkmcnt(0)
    s_mov_b64 exec, 1
    ds_add_u32 v124, v127 offset:452
    s_mov_b64 exec, -1
.Laux_qdone:
    s_cmp_lt_u32 s25, 6
    s_cbranch_scc1 .Laux_wddone
    s_cmp_lg_u32 s3, 3
    s_cbranch_scc1 .Laux_hwait
    v_mul_u32_u24 v1, 12288, v14
    v_lshl_add_u32 v1, v13, 4, v1
    s_mul_i32 s52, s55, 192
    s_add_u32 s52, s52, 524288
    s_add_u32 s53, s52, 49152
    s_add_u32 s54, s52, 98304
    s_add_u32 s57, s52, 147456
    v_lshlrev_b32 v6, 2, v13
    s_mov_b32 s27, 320000
.lw_9:
    ds_read_b32 v3, v124 offset:448
    s_waitcnt lgkmcnt(0)
    v_readfirstlane_b32 s40, v3
    s_cmp_ge_u32 s40, 16
    s_cbranch_scc1 .lwd_10
    s_sub_u32 s27, s27, 1
    s_cbranch_scc0 .lw_9
.lwd_10:
    s_mov_b32 exec_lo, 0x0fff0fff
    s_mov_b32 exec_hi, 0x0fff0fff
    s_mov_b32 s27, 40000
.poll_11:
    buffer_load_dwordx4 v[100:103], v1, s[12:15], s52 offen sc1
    buffer_load_dwordx4 v[104:107], v1, s[12:15], s53 offen sc1
    buffer_load_dwordx4 v[108:111], v1, s[12:15], s54 offen sc1
    buffer_load_dwordx4 v[112:115], v1, s[12:15], s57 offen sc1
    s_waitcnt vmcnt(0)
    v_cmp_ne_u32 s[40:41], s26, v101
    v_cmp_ne_u32 s[42:43], s26, v103
    s_or_b64 s[40:41], s[40:41], s[42:43]
    v_cmp_ne_u32 s[42:43], s26, v105
    s_or_b64 s[40:41], s[40:41], s[42:43]
    v_cmp_ne_u32 s[42:43], s26, v107
    s_or_b64 s[40:41], s[40:41], s[42:43]
    v_cmp_ne_u32 s[42:43], s26, v109
    s_or_b64 s[40:41], s[40:41], s[42:43]
    v_cmp_ne_u32 s[42:43], s26, v111
    s_or_b64 s[40:41], s[40:41], s[42:43]
    v_cmp_ne_u32 s[42:43], s26, v113
    s_or_b64 s[40:41], s[40:41], s[42:43]
    v_cmp_ne_u32 s[42:43], s26, v115
    s_or_b64 s[40:41], s[40:41], s[42:43]
    s_cmp_eq_u64 s[40:41], 0
    s_cbranch_scc1 .polld_12
    s_sub_u32 s27, s27, 1
    s_cbranch_scc0 .poll_11
.polld_12:
    v_add_f32 v100, v100, v104
    v_add_f32 v108, v108, v112
    v_add_f32 v102, v102, v106
    v_add_f32 v110, v110, v114
    v_mov_b32 v101, v100
    v_mov_b32 v103, v102
    v_mov_b32 v109, v108
    v_mov_b32 v111, v110
    v_permlane16_swap_b32 v100, v101
    v_permlane16_swap_b32 v102, v103
    v_permlane16_swap_b32 v108, v109
    v_permlane16_swap_b32 v110, v111
    v_add_f32 v100, v100, v101
    v_add_f32 v102, v102, v103
    v_add_f32 v108, v108, v109
    v_add_f32 v110, v110, v111
    v_mov_b32 v101, v100
    v_mov_b32 v103, v102
    v_mov_b32 v109, v108
    v_mov_b32 v111, v110
    v_permlane32_swap_b32 v100, v101
    v_permlane32_swap_b32 v102, v103
    v_permlane32_swap_b32 v108, v109
    v_permlane32_swap_b32 v110, v111
    v_add_f32 v100, v100, v101
    v_add_f32 v102, v102, v103
    v_add_f32 v108, v108, v109
    v_add_f32 v110, v110, v111
    v_cvt_pk_bf16_f32 v100, v100, v100
    s_branch .Lskip_2
.Lpad_2:
    s_branch .Lbulk2
.Lskip_2:
    v_lshlrev_b32 v100, 16, v100
    v_cvt_pk_bf16_f32 v102, v102, v102
    v_lshlrev_b32 v102, 16, v102
    v_cvt_pk_bf16_f32 v108, v108, v108
    v_lshlrev_b32 v108, 16, v108
    v_cvt_pk_bf16_f32 v110, v110, v110
    v_lshlrev_b32 v110, 16, v110
    v_mul_f32 v100, 0xbfb8aa3b, v100
    v_exp_f32 v100, v100
    s_nop 0
    v_add_f32 v100, 1.0, v100
    v_rcp_f32 v100, v100
    s_nop 0
    v_cvt_pk_bf16_f32 v100, v100, v100
    v_lshlrev_b32 v100, 16, v100
    v_mul_f32 v100, v100, v108
    v_mul_f32 v102, 0xbfb8aa3b, v102
    v_exp_f32 v102, v102
    s_nop 0
    v_add_f32 v102, 1.0, v102
    v_rcp_f32 v102, v102
    s_nop 0
    v_cvt_pk_bf16_f32 v102, v102, v102
    v_lshlrev_b32 v102, 16, v102
    v_mul_f32 v102, v102, v110
    v_cvt_pk_bf16_f32 v100, v100, v102
    ds_write_b32 v6, v100 offset:10560
    s_waitcnt lgkmcnt(0)
    s_mov_b64 exec, 1
    ds_write_b32 v124, v127 offset:464
    s_mov_b64 exec, -1
.Laux_hwait:
    s_mul_i32 s56, s3, 86016
    s_lshl_b32 s53, s55, 6
    s_add_u32 s56, s56, s53
    s_add_u32 s56, s56, 1572864
    v_mov_b32 v41, s26
    v_mov_b32 v43, s26
    s_mov_b32 s27, 320000
.lw_13:
    ds_read_b32 v3, v124 offset:464
    ds_read_u16 v100, v12 offset:10560
    ds_read_u16 v101, v12 offset:10576
    ds_read_u16 v102, v12 offset:10592
    s_waitcnt lgkmcnt(0)
    v_readfirstlane_b32 s40, v3
    s_cmp_ge_u32 s40, 1
    s_cbranch_scc1 .lwd_14
    s_sub_u32 s27, s27, 1
    s_cbranch_scc0 .lw_13
.lwd_14:
    s_waitcnt vmcnt(0)
    v_lshlrev_b32 v100, v2, v100
    v_cndmask_b32 v24, 0, v100, s[32:33]
    v_cndmask_b32 v25, 0, v100, s[34:35]
    v_cndmask_b32 v26, 0, v100, s[36:37]
    v_cndmask_b32 v27, 0, v100, s[38:39]
    s_nop 1
    v_mfma_f32_16x16x32_bf16 v[116:119], v[24:27], v[76:79], 0
    v_mfma_f32_16x16x32_bf16 v[120:123], v[24:27], v[80:83], 0
    v_lshlrev_b32 v101, v2, v101
    v_cndmask_b32 v28, 0, v101, s[32:33]
    v_cndmask_b32 v29, 0, v101, s[34:35]
    v_cndmask_b32 v30, 0, v101, s[36:37]
    v_cndmask_b32 v31, 0, v101, s[38:39]
    s_nop 1
    v_mfma_f32_16x16x32_bf16 v[116:119], v[28:31], v[84:87], v[116:119]
    v_mfma_f32_16x16x32_bf16 v[120:123], v[28:31], v[88:91], v[120:123]
    v_lshlrev_b32 v102, v2, v102
    v_cndmask_b32 v32, 0, v102, s[32:33]
    v_cndmask_b32 v33, 0, v102, s[34:35]
    v_cndmask_b32 v34, 0, v102, s[36:37]
    v_cndmask_b32 v35, 0, v102, s[38:39]
    s_nop 1
    v_mfma_f32_16x16x32_bf16 v[116:119], v[32:35], v[92:95], v[116:119]
    v_mfma_f32_16x16x32_bf16 v[120:123], v[32:35], v[96:99], v[120:123]
    s_nop 7
    v_permlane32_swap_b32 v116, v120
    v_permlane32_swap_b32 v117, v121
    v_permlane32_swap_b32 v118, v122
    v_permlane32_swap_b32 v119, v123
    v_add_f32_dpp v40, v120, v116 row_ror:8 row_mask:0xf bank_mask:0x3
    v_add_f32_dpp v42, v121, v117 row_ror:8 row_mask:0xf bank_mask:0x3
    s_nop 0
    v_add_f32_dpp v40, v118, v122 row_ror:8 row_mask:0xf bank_mask:0xc
    v_add_f32_dpp v42, v119, v123 row_ror:8 row_mask:0xf bank_mask:0xc
.Laux_wddone:
    s_cmp_lg_u32 s3, 4
    s_cbranch_scc1 .Laux_s2
    v_lshlrev_b32 v1, 4, v0
    v_lshlrev_b32 v6, 3, v0
    s_lshl_b32 s52, s24, 10
    s_add_u32 s52, s52, 786432
    s_lshl_b32 s53, s25, 7
    s_add_u32 s53, s53, s52
    s_getreg_b32 s57, hwreg(HW_REG_XCC_ID, 0, 4)
    v_mov_b32 v106, s57
    v_mov_b32 v107, s26
    s_mov_b32 s27, 320000
.lw_15:
    ds_read_b32 v3, v124 offset:468
    ds_read_b64 v[104:105], v6 offset:10624
    s_waitcnt lgkmcnt(0)
    v_readfirstlane_b32 s40, v3
    s_cmp_ge_u32 s40, 8
    s_cbranch_scc1 .lwd_16
    s_sub_u32 s27, s27, 1
    s_cbranch_scc0 .lw_15
.lwd_16:
    s_mov_b64 exec, 0xff
    buffer_store_dwordx4 v[104:107], v1, s[12:15], s53 offen
    s_mov_b64 exec, -1
    s_mov_b32 s27, 320000
.lw_17:
    ds_read_b32 v3, v124 offset:448
    s_waitcnt lgkmcnt(0)
    v_readfirstlane_b32 s40, v3
    s_cmp_ge_u32 s40, 36
    s_cbranch_scc1 .lwd_18
    s_sub_u32 s27, s27, 1
    s_cbranch_scc0 .lw_17
.lwd_18:
    s_mov_b32 s27, 10000
    s_mov_b32 s62, 23
.poll_19:
    buffer_load_dwordx4 v[100:103], v1, s[12:15], s52 offen sc1
    s_waitcnt vmcnt(0)
    v_cmp_ne_u32 s[40:41], s26, v103
    s_cmp_eq_u64 s[40:41], 0
    s_cbranch_scc1 .polld_20
    s_sub_u32 s62, s62, 1
    s_cbranch_scc0 .poll_19
    s_mov_b32 s62, 2
    buffer_wbl2 sc1
    s_waitcnt vmcnt(0)
    s_sub_u32 s27, s27, 1
    s_cbranch_scc0 .poll_19
.polld_20:
    v_cmp_ne_u32 s[40:41], s57, v102
    v_mov_b32 v21, 1
    s_cmp_eq_u64 s[40:41], 0
    s_cbranch_scc1 .Laux_same
    buffer_wbl2 sc1
    v_mov_b32 v21, 2
    s_waitcnt vmcnt(0)
.Laux_same:
    v_mov_b32 v16, v100
    s_nop 1
    v_max_f32_dpp v16, v16, v16 quad_perm:[1,0,3,2] row_mask:0xf bank_mask:0xf
    s_nop 1
    v_max_f32_dpp v16, v16, v16 quad_perm:[2,3,0,1] row_mask:0xf bank_mask:0xf
    s_nop 1
    v_max_f32_dpp v16, v16, v16 row_half_mirror row_mask:0xf bank_mask:0xf
    s_nop 1
    v_max_f32_dpp v16, v16, v16 row_ror:8 row_mask:0xf bank_mask:0xf
    v_mov_b32 v18, v16
    s_nop 1
    v_permlane16_swap_b32 v16, v18
    v_max_f32 v16, v16, v18
    v_mov_b32 v18, v16
    s_nop 1
    v_permlane32_swap_b32 v16, v18
    v_max_f32 v16, v16, v18
    v_sub_f32 v17, v100, v16
    v_mul_f32 v17, 0x3fb8aa3b, v17
    v_exp_f32 v17, v17
    s_nop 0
    v_mul_f32 v17, v17, v101
    s_nop 1
    v_add_f32_dpp v17, v17, v17 quad_perm:[1,0,3,2] row_mask:0xf bank_mask:0xf
    s_nop 1
    v_add_f32_dpp v17, v17, v17 quad_perm:[2,3,0,1] row_mask:0xf bank_mask:0xf
    s_nop 1
    v_add_f32_dpp v17, v17, v17 row_half_mirror row_mask:0xf bank_mask:0xf
    s_nop 1
    v_add_f32_dpp v17, v17, v17 row_ror:8 row_mask:0xf bank_mask:0xf
    v_mov_b32 v18, v17
    s_nop 1
    v_permlane16_swap_b32 v17, v18
    v_add_f32 v17, v17, v18
    v_mov_b32 v18, v17
    s_nop 1
    v_permlane32_swap_b32 v17, v18
    v_add_f32 v17, v17, v18
    v_rcp_f32 v17, v17
    s_mov_b64 exec, 1
    ds_write_b64 v124, v[16:17] offset:384
    s_waitcnt lgkmcnt(0)
    ds_write_b32 v124, v21 offset:456
    s_mov_b64 exec, -1
.Laux_s2:
    v_mul_u32_u24 v7, 3840, v4
    v_lshl_add_u32 v7, v5, 4, v7
    s_mul_i32 s52, s24, 192
    s_mul_i32 s53, s25, 24
    s_add_u32 s52, s52, s53
    s_mul_i32 s52, s52, 1280
    s_lshl_b32 s53, s3, 8
    s_add_u32 s52, s52, s53
    v_lshlrev_b32 v17, 4, v0
    s_lshl_b32 s54, s24, 13
    s_lshl_b32 s53, s25, 10
    s_add_u32 s54, s54, s53
    s_add_u32 s54, s54, 1048576
    v_mov_b32 v9, s26
    v_mov_b32 v11, s26
    v_mov_b32 v22, 0xffff
    v_lshlrev_b32 v22, v2, v22
    s_mul_i32 s60, s3, 282624
    s_lshl_b32 s53, s24, 9
    s_add_u32 s60, s60, s53
    s_lshl_b32 s53, s25, 6
    s_add_u32 s60, s60, s53
    s_add_u32 s60, s60, 2097152
    s_lshl_b32 s53, s3, 2
    s_lshr_b32 s61, 0x88888, s53
    s_and_b32 s61, s61, 15
    s_mov_b32 s27, 320000
.lw_21:
    ds_read_b32 v3, v124 offset:460
    s_waitcnt lgkmcnt(0)
    v_readfirstlane_b32 s40, v3
    s_cmp_ge_u32 s40, s61
    s_cbranch_scc1 .lwd_22
    s_sub_u32 s27, s27, 1
    s_cbranch_scc0 .lw_21
.lwd_22:
    buffer_load_dwordx4 v[76:79], v7, s[8:11], s52 offen offset:0 nt
    buffer_load_dwordx4 v[80:83], v7, s[8:11], s52 offen offset:128 nt
    s_add_u32 s52, s52, 1280
    buffer_load_dwordx4 v[84:87], v7, s[8:11], s52 offen offset:0 nt
    buffer_load_dwordx4 v[88:91], v7, s[8:11], s52 offen offset:128 nt
    s_add_u32 s52, s52, 1280
    buffer_load_dwordx4 v[92:95], v7, s[8:11], s52 offen offset:0 nt
    buffer_load_dwordx4 v[96:99], v7, s[8:11], s52 offen offset:128 nt
    s_barrier
    s_mov_b32 s27, 40000
.poll_23:
    buffer_load_dwordx4 v[100:103], v17, s[12:15], s54 offen sc1
    s_waitcnt vmcnt(0)
    v_cmp_ne_u32 s[40:41], s26, v103
    s_cmp_eq_u64 s[40:41], 0
    s_cbranch_scc1 .polld_24
    s_sub_u32 s27, s27, 1
    s_cbranch_scc0 .poll_23
.polld_24:
    s_cmp_lt_u32 s25, 6
    s_branch .Lskip_3
.Lpad_3:
    s_branch .Lbulk2
.Lskip_3:
    s_cbranch_scc1 .Laux_nob
    buffer_store_dwordx4 v[40:43], v19, s[12:15], s56 offen sc1
.Laux_nob:
    v_add_f32_dpp v100, v100, v100 quad_perm:[1,0,3,2] row_mask:0xf bank_mask:0xf
    v_add_f32_dpp v101, v101, v101 quad_perm:[1,0,3,2] row_mask:0xf bank_mask:0xf
    v_add_f32_dpp v102, v102, v102 quad_perm:[1,0,3,2] row_mask:0xf bank_mask:0xf
    v_add_f32_dpp v100, v100, v100 quad_perm:[2,3,0,1] row_mask:0xf bank_mask:0xf
    v_add_f32_dpp v101, v101, v101 quad_perm:[2,3,0,1] row_mask:0xf bank_mask:0xf
    v_add_f32_dpp v102, v102, v102 quad_perm:[2,3,0,1] row_mask:0xf bank_mask:0xf
    v_add_f32_dpp v100, v100, v100 row_half_mirror row_mask:0xf bank_mask:0xf
    v_add_f32_dpp v101, v101, v101 row_half_mirror row_mask:0xf bank_mask:0xf
    v_add_f32_dpp v102, v102, v102 row_half_mirror row_mask:0xf bank_mask:0xf
    v_cvt_pk_bf16_f32 v100, v100, v100
    v_and_b32 v100, v100, v22
    v_cndmask_b32 v24, 0, v100, s[32:33]
    v_cndmask_b32 v25, 0, v100, s[34:35]
    v_cndmask_b32 v26, 0, v100, s[36:37]
    v_cndmask_b32 v27, 0, v100, s[38:39]
    s_nop 1
    v_mfma_f32_16x16x32_bf16 v[116:119], v[24:27], v[76:79], 0
    v_mfma_f32_16x16x32_bf16 v[120:123], v[24:27], v[80:83], 0
    v_cvt_pk_bf16_f32 v101, v101, v101
    v_and_b32 v101, v101, v22
    v_cndmask_b32 v28, 0, v101, s[32:33]
    v_cndmask_b32 v29, 0, v101, s[34:35]
    v_cndmask_b32 v30, 0, v101, s[36:37]
    v_cndmask_b32 v31, 0, v101, s[38:39]
    s_nop 1
    v_mfma_f32_16x16x32_bf16 v[116:119], v[28:31], v[84:87], v[116:119]
    v_mfma_f32_16x16x32_bf16 v[120:123], v[28:31], v[88:91], v[120:123]
    v_cvt_pk_bf16_f32 v102, v102, v102
    v_and_b32 v102, v102, v22
    v_cndmask_b32 v32, 0, v102, s[32:33]
    v_cndmask_b32 v33, 0, v102, s[34:35]
    v_cndmask_b32 v34, 0, v102, s[36:37]
    v_cndmask_b32 v35, 0, v102, s[38:39]
    s_nop 1
    v_mfma_f32_16x16x32_bf16 v[116:119], v[32:35], v[92:95], v[116:119]
    v_mfma_f32_16x16x32_bf16 v[120:123], v[32:35], v[96:99], v[120:123]
    s_nop 7
    v_permlane32_swap_b32 v116, v120
    v_permlane32_swap_b32 v117, v121
    v_permlane32_swap_b32 v118, v122
    v_permlane32_swap_b32 v119, v123
    v_add_f32_dpp v8, v120, v116 row_ror:8 row_mask:0xf bank_mask:0x3
    v_add_f32_dpp v10, v121, v117 row_ror:8 row_mask:0xf bank_mask:0x3
    s_nop 0
    v_add_f32_dpp v8, v118, v122 row_ror:8 row_mask:0xf bank_mask:0xc
    v_add_f32_dpp v10, v119, v123 row_ror:8 row_mask:0xf bank_mask:0xc
    buffer_store_dwordx4 v[8:11], v20, s[12:15], s60 offen sc1
    s_cmp_lt_u32 s3, 3
    s_cbranch_scc1 .Laux_nogu
    s_cmp_ge_u32 s25, 6
    s_cbranch_scc1 .Laux_nogu
.Laux_gu:
    s_mov_b32 exec_hi, 0
    buffer_store_dwordx4 v[36:39], v17, s[12:15], s51 offen sc1
.Laux_nogu:
    s_lshl_b32 s40, s24, 3
    s_or_b32 s40, s40, s25
    s_waitcnt vmcnt(0)
    s_cmp_ge_u32 s40, 80
    s_cbranch_scc1 .Laux_end
    s_barrier
.Laux_end:
.Lend:
    s_endpgm
.Lbulk2:
    s_barrier
    s_waitcnt vmcnt(2)
    buffer_load_dwordx4 v[44:47], v1, s[4:7], s28 offen offset:3072 nt
    s_waitcnt vmcnt(2)
    buffer_load_dwordx4 v[48:51], v1, s[4:7], s28 offen offset:3200 nt
    s_waitcnt vmcnt(2)
    buffer_load_dwordx4 v[52:55], v1, s[4:7], s28 offen offset:3328 nt
    s_waitcnt vmcnt(2)
    buffer_load_dwordx4 v[56:59], v1, s[4:7], s29 offen offset:0 nt
    s_waitcnt vmcnt(2)
    buffer_load_dwordx4 v[60:63], v1, s[4:7], s29 offen offset:128 nt
    s_waitcnt vmcnt(2)
    buffer_load_dwordx4 v[64:67], v1, s[4:7], s29 offen offset:256 nt
    s_waitcnt vmcnt(2)
    buffer_load_dwordx4 v[68:71], v1, s[4:7], s29 offen offset:3072 nt
    s_waitcnt vmcnt(2)
    buffer_load_dwordx4 v[72:75], v1, s[4:7], s29 offen offset:3200 nt
    s_waitcnt vmcnt(2)
    buffer_load_dwordx4 v[76:79], v1, s[4:7], s29 offen offset:3328 nt
    s_mov_b64 exec, 1
    v_mov_b32 v28, 0
    v_mov_b32 v29, 12
    ds_max_u32 v28, v29 offset:448
    s_mov_b64 exec, -1
    s_waitcnt vmcnt(2)
    buffer_load_dwordx4 v[80:83], v1, s[4:7], s30 offen offset:0 nt
    s_waitcnt vmcnt(2)
    buffer_load_dwordx4 v[84:87], v1, s[4:7], s30 offen offset:128 nt
    s_waitcnt vmcnt(2)
    buffer_load_dwordx4 v[88:91], v1, s[4:7], s30 offen offset:256 nt
    s_waitcnt vmcnt(2)
    buffer_load_dwordx4 v[92:95], v1, s[4:7], s30 offen offset:3072 nt
    s_mov_b64 exec, 1
    v_mov_b32 v28, 0
    v_mov_b32 v29, 16
    ds_max_u32 v28, v29 offset:448
    s_mov_b64 exec, -1
    s_waitcnt vmcnt(2)
    buffer_load_dwordx4 v[96:99], v1, s[4:7], s30 offen offset:3200 nt
    s_waitcnt vmcnt(2)
    buffer_load_dwordx4 v[100:103], v1, s[4:7], s30 offen offset:3328 nt
    s_waitcnt vmcnt(2)
    buffer_load_dwordx4 v[104:107], v1, s[4:7], s31 offen offset:0 nt
    s_waitcnt vmcnt(2)
    buffer_load_dwordx4 v[108:111], v1, s[4:7], s31 offen offset:128 nt
    s_waitcnt vmcnt(2)
    buffer_load_dwordx4 v[112:115], v1, s[4:7], s31 offen offset:256 nt
    s_waitcnt vmcnt(2)
    buffer_load_dwordx4 v[116:119], v1, s[4:7], s31 offen offset:3072 nt
    s_waitcnt vmcnt(2)
    buffer_load_dwordx4 v[120:123], v1, s[4:7], s31 offen offset:3200 nt
    s_waitcnt vmcnt(2)
    buffer_load_dwordx4 v[124:127], v1, s[4:7], s31 offen offset:3328 nt
    s_waitcnt lgkmcnt(0)
    s_mul_i32 s26, s26, 0x19660d
    s_add_u32 s26, s26, 0x3c6ef35f
    s_mov_b32 s27, 320000
.lw_1:
    ds_read_b32 v3, v6 offset:452
    ds_read_b128 v[8:11], v6 offset:0
    ds_read_b128 v[12:15], v6 offset:128
    ds_read_b128 v[16:19], v6 offset:256
    s_waitcnt lgkmcnt(0)
    v_readfirstlane_b32 s40, v3
    s_cmp_ge_u32 s40, 3
    s_cbranch_scc1 .lwd_2
    s_sub_u32 s27, s27, 1
    s_cbranch_scc0 .lw_1
.lwd_2:
    v_dot2_f32_bf16 v3, v32, v8, 0
    v_dot2_f32_bf16 v4, v36, v12, 0
    v_dot2_f32_bf16 v5, v40, v16, 0
    v_dot2_f32_bf16 v3, v33, v9, v3
    v_dot2_f32_bf16 v4, v37, v13, v4
    v_dot2_f32_bf16 v5, v41, v17, v5
    v_dot2_f32_bf16 v3, v34, v10, v3
    v_dot2_f32_bf16 v4, v38, v14, v4
    v_dot2_f32_bf16 v5, v42, v18, v5
    v_dot2_f32_bf16 v3, v35, v11, v3
    v_dot2_f32_bf16 v4, v39, v15, v4
    v_dot2_f32_bf16 v5, v43, v19, v5
    s_nop 1
    v_add_f32 v3, v3, v4
    v_add_f32 v3, v3, v5
    s_nop 1
    v_add_f32_dpp v3, v3, v3 quad_perm:[1,0,3,2] row_mask:0xf bank_mask:0xf
    s_nop 1
    v_add_f32_dpp v3, v3, v3 quad_perm:[2,3,0,1] row_mask:0xf bank_mask:0xf
    s_nop 1
    v_add_f32_dpp v3, v3, v3 row_half_mirror row_mask:0xf bank_mask:0xf
    v_cvt_pk_bf16_f32 v3, v3, v3
    v_lshlrev_b32 v3, 16, v3
    v_mul_f32 v3, 0x3d93cd3a, v3
    v_cvt_pk_bf16_f32 v20, v3, v3
    v_lshlrev_b32 v20, 16, v20
    v_dot2_f32_bf16 v3, v44, v8, 0
    v_dot2_f32_bf16 v4, v48, v12, 0
    v_dot2_f32_bf16 v5, v52, v16, 0
    v_dot2_f32_bf16 v3, v45, v9, v3
    v_dot2_f32_bf16 v4, v49, v13, v4
    v_dot2_f32_bf16 v5, v53, v17, v5
    v_dot2_f32_bf16 v3, v46, v10, v3
    v_dot2_f32_bf16 v4, v50, v14, v4
    v_dot2_f32_bf16 v5, v54, v18, v5
    v_dot2_f32_bf16 v3, v47, v11, v3
    v_dot2_f32_bf16 v4, v51, v15, v4
    v_dot2_f32_bf16 v5, v55, v19, v5
    s_nop 1
    v_add_f32 v3, v3, v4
    v_add_f32 v3, v3, v5
    s_nop 1
    v_add_f32_dpp v3, v3, v3 quad_perm:[1,0,3,2] row_mask:0xf bank_mask:0xf
    s_nop 1
    v_add_f32_dpp v3, v3, v3 quad_perm:[2,3,0,1] row_mask:0xf bank_mask:0xf
    s_nop 1
    v_add_f32_dpp v3, v3, v3 row_half_mirror row_mask:0xf bank_mask:0xf
    v_cvt_pk_bf16_f32 v3, v3, v3
    v_lshlrev_b32 v3, 16, v3
    v_mul_f32 v3, 0x3d93cd3a, v3
    v_cvt_pk_bf16_f32 v21, v3, v3
    v_lshlrev_b32 v21, 16, v21
    s_waitcnt vmcnt(2)
    buffer_load_dwordx4 v[32:35], v1, s[8:11], s28 offen offset:0 nt
    v_dot2_f32_bf16 v3, v56, v8, 0
    v_dot2_f32_bf16 v4, v60, v12, 0
    v_dot2_f32_bf16 v5, v64, v16, 0
    v_dot2_f32_bf16 v3, v57, v9, v3
    v_dot2_f32_bf16 v4, v61, v13, v4
    v_dot2_f32_bf16 v5, v65, v17, v5
    v_dot2_f32_bf16 v3, v58, v10, v3
    v_dot2_f32_bf16 v4, v62, v14, v4
    v_dot2_f32_bf16 v5, v66, v18, v5
    v_dot2_f32_bf16 v3, v59, v11, v3
    v_dot2_f32_bf16 v4, v63, v15, v4
    v_dot2_f32_bf16 v5, v67, v19, v5
    s_nop 1
    v_add_f32 v3, v3, v4
    v_add_f32 v3, v3, v5
    s_nop 1
    v_add_f32_dpp v3, v3, v3 quad_perm:[1,0,3,2] row_mask:0xf bank_mask:0xf
    s_branch .Lskip_4
.Lpad_4:
    s_branch .Lbulk2
.Lskip_4:
    s_nop 1
    v_add_f32_dpp v3, v3, v3 quad_perm:[2,3,0,1] row_mask:0xf bank_mask:0xf
    s_nop 1
    v_add_f32_dpp v3, v3, v3 row_half_mirror row_mask:0xf bank_mask:0xf
    v_cvt_pk_bf16_f32 v3, v3, v3
    v_lshlrev_b32 v3, 16, v3
    v_mul_f32 v3, 0x3d93cd3a, v3
    v_cvt_pk_bf16_f32 v22, v3, v3
    v_lshlrev_b32 v22, 16, v22
    v_dot2_f32_bf16 v3, v68, v8, 0
    v_dot2_f32_bf16 v4, v72, v12, 0
    v_dot2_f32_bf16 v5, v76, v16, 0
    v_dot2_f32_bf16 v3, v69, v9, v3
    v_dot2_f32_bf16 v4, v73, v13, v4
    v_dot2_f32_bf16 v5, v77, v17, v5
    v_dot2_f32_bf16 v3, v70, v10, v3
    v_dot2_f32_bf16 v4, v74, v14, v4
    v_dot2_f32_bf16 v5, v78, v18, v5
    v_dot2_f32_bf16 v3, v71, v11, v3
    v_dot2_f32_bf16 v4, v75, v15, v4
    v_dot2_f32_bf16 v5, v79, v19, v5
    s_nop 1
    v_add_f32 v3, v3, v4
    v_add_f32 v3, v3, v5
    s_nop 1
    v_add_f32_dpp v3, v3, v3 quad_perm:[1,0,3,2] row_mask:0xf bank_mask:0xf
    s_nop 1
    v_add_f32_dpp v3, v3, v3 quad_perm:[2,3,0,1] row_mask:0xf bank_mask:0xf
    s_nop 1
    v_add_f32_dpp v3, v3, v3 row_half_mirror row_mask:0xf bank_mask:0xf
    v_cvt_pk_bf16_f32 v3, v3, v3
    v_lshlrev_b32 v3, 16, v3
    v_mul_f32 v3, 0x3d93cd3a, v3
    v_cvt_pk_bf16_f32 v23, v3, v3
    v_lshlrev_b32 v23, 16, v23
    s_waitcnt vmcnt(2)
    buffer_load_dwordx4 v[36:39], v1, s[8:11], s28 offen offset:128 nt
    v_dot2_f32_bf16 v3, v80, v8, 0
    v_dot2_f32_bf16 v4, v84, v12, 0
    v_dot2_f32_bf16 v5, v88, v16, 0
    v_dot2_f32_bf16 v3, v81, v9, v3
    v_dot2_f32_bf16 v4, v85, v13, v4
    v_dot2_f32_bf16 v5, v89, v17, v5
    v_dot2_f32_bf16 v3, v82, v10, v3
    v_dot2_f32_bf16 v4, v86, v14, v4
    v_dot2_f32_bf16 v5, v90, v18, v5
    v_dot2_f32_bf16 v3, v83, v11, v3
    v_dot2_f32_bf16 v4, v87, v15, v4
    v_dot2_f32_bf16 v5, v91, v19, v5
    s_nop 1
    v_add_f32 v3, v3, v4
    v_add_f32 v3, v3, v5
    s_nop 1
    v_add_f32_dpp v3, v3, v3 quad_perm:[1,0,3,2] row_mask:0xf bank_mask:0xf
    s_nop 1
    v_add_f32_dpp v3, v3, v3 quad_perm:[2,3,0,1] row_mask:0xf bank_mask:0xf
    s_nop 1
    v_add_f32_dpp v3, v3, v3 row_half_mirror row_mask:0xf bank_mask:0xf
    v_cvt_pk_bf16_f32 v3, v3, v3
    v_lshlrev_b32 v3, 16, v3
    v_mul_f32 v3, 0x3d93cd3a, v3
    v_cvt_pk_bf16_f32 v24, v3, v3
    v_lshlrev_b32 v24, 16, v24
    v_dot2_f32_bf16 v3, v92, v8, 0
    v_dot2_f32_bf16 v4, v96, v12, 0
    v_dot2_f32_bf16 v5, v100, v16, 0
    v_dot2_f32_bf16 v3, v93, v9, v3
    v_dot2_f32_bf16 v4, v97, v13, v4
    v_dot2_f32_bf16 v5, v101, v17, v5
    v_dot2_f32_bf16 v3, v94, v10, v3
    v_dot2_f32_bf16 v4, v98, v14, v4
    v_dot2_f32_bf16 v5, v102, v18, v5
    v_dot2_f32_bf16 v3, v95, v11, v3
    v_dot2_f32_bf16 v4, v99, v15, v4
    v_dot2_f32_bf16 v5, v103, v19, v5
    s_nop 1
    v_add_f32 v3, v3, v4
    v_add_f32 v3, v3, v5
    s_nop 1
    v_add_f32_dpp v3, v3, v3 quad_perm:[1,0,3,2] row_mask:0xf bank_mask:0xf
    s_nop 1
    v_add_f32_dpp v3, v3, v3 quad_perm:[2,3,0,1] row_mask:0xf bank_mask:0xf
    s_nop 1
    v_add_f32_dpp v3, v3, v3 row_half_mirror row_mask:0xf bank_mask:0xf
    v_cvt_pk_bf16_f32 v3, v3, v3
    v_lshlrev_b32 v3, 16, v3
    v_mul_f32 v3, 0x3d93cd3a, v3
    v_cvt_pk_bf16_f32 v25, v3, v3
    v_lshlrev_b32 v25, 16, v25
    s_waitcnt vmcnt(2)
    buffer_load_dwordx4 v[40:43], v1, s[8:11], s28 offen offset:256 nt
    v_dot2_f32_bf16 v3, v104, v8, 0
    v_dot2_f32_bf16 v4, v108, v12, 0
    v_dot2_f32_bf16 v5, v112, v16, 0
    v_dot2_f32_bf16 v3, v105, v9, v3
    v_dot2_f32_bf16 v4, v109, v13, v4
    v_dot2_f32_bf16 v5, v113, v17, v5
    v_dot2_f32_bf16 v3, v106, v10, v3
    v_dot2_f32_bf16 v4, v110, v14, v4
    v_dot2_f32_bf16 v5, v114, v18, v5
    v_dot2_f32_bf16 v3, v107, v11, v3
    v_dot2_f32_bf16 v4, v111, v15, v4
    v_dot2_f32_bf16 v5, v115, v19, v5
    s_nop 1
    v_add_f32 v3, v3, v4
    v_add_f32 v3, v3, v5
    s_nop 1
    v_add_f32_dpp v3, v3, v3 quad_perm:[1,0,3,2] row_mask:0xf bank_mask:0xf
    s_nop 1
    v_add_f32_dpp v3, v3, v3 quad_perm:[2,3,0,1] row_mask:0xf bank_mask:0xf
    s_nop 1
    v_add_f32_dpp v3, v3, v3 row_half_mirror row_mask:0xf bank_mask:0xf
    v_cvt_pk_bf16_f32 v3, v3, v3
    v_lshlrev_b32 v3, 16, v3
    v_mul_f32 v3, 0x3d93cd3a, v3
    v_cvt_pk_bf16_f32 v26, v3, v3
    v_lshlrev_b32 v26, 16, v26
    v_dot2_f32_bf16 v3, v116, v8, 0
    v_dot2_f32_bf16 v4, v120, v12, 0
    v_dot2_f32_bf16 v5, v124, v16, 0
    v_dot2_f32_bf16 v3, v117, v9, v3
    v_dot2_f32_bf16 v4, v121, v13, v4
    v_dot2_f32_bf16 v5, v125, v17, v5
    v_dot2_f32_bf16 v3, v118, v10, v3
    v_dot2_f32_bf16 v4, v122, v14, v4
    v_dot2_f32_bf16 v5, v126, v18, v5
    v_dot2_f32_bf16 v3, v119, v11, v3
    v_dot2_f32_bf16 v4, v123, v15, v4
    v_dot2_f32_bf16 v5, v127, v19, v5
    s_nop 1
    v_add_f32 v3, v3, v4
    v_add_f32 v3, v3, v5
    s_nop 1
    v_add_f32_dpp v3, v3, v3 quad_perm:[1,0,3,2] row_mask:0xf bank_mask:0xf
    s_nop 1
    v_add_f32_dpp v3, v3, v3 quad_perm:[2,3,0,1] row_mask:0xf bank_mask:0xf
    s_nop 1
    v_add_f32_dpp v3, v3, v3 row_half_mirror row_mask:0xf bank_mask:0xf
    v_cvt_pk_bf16_f32 v3, v3, v3
    v_lshlrev_b32 v3, 16, v3
    v_mul_f32 v3, 0x3d93cd3a, v3
    v_cvt_pk_bf16_f32 v27, v3, v3
    v_lshlrev_b32 v27, 16, v27
    v_max3_f32 v7, v20, v21, v22
    v_max3_f32 v3, v23, v24, v25
    v_max3_f32 v7, v7, v26, v27
    v_max_f32 v7, v7, v3
    s_nop 1
    v_max_f32_dpp v7, v7, v7 row_ror:8 row_mask:0xf bank_mask:0xf
    v_mov_b32 v3, v7
    s_nop 1
    v_permlane16_swap_b32 v7, v3
    v_max_f32 v7, v7, v3
    v_mov_b32 v3, v7
    s_nop 1
    v_permlane32_swap_b32 v7, v3
    v_max_f32 v7, v7, v3
    v_mul_f32 v4, 0x3fb8aa3b, v7
    s_mov_b32 s49, 0x3fb8aa3b
    v_fma_f32 v20, v20, s49, -v4
    v_fma_f32 v21, v21, s49, -v4
    v_fma_f32 v22, v22, s49, -v4
    v_fma_f32 v23, v23, s49, -v4
    v_fma_f32 v24, v24, s49, -v4
    v_fma_f32 v25, v25, s49, -v4
    v_fma_f32 v26, v26, s49, -v4
    v_fma_f32 v27, v27, s49, -v4
    v_exp_f32 v20, v20
    v_exp_f32 v21, v21
    v_exp_f32 v22, v22
    v_exp_f32 v23, v23
    v_exp_f32 v24, v24
    v_exp_f32 v25, v25
    v_exp_f32 v26, v26
    v_exp_f32 v27, v27
    v_add_f32 v5, v20, v21
    v_add_f32 v6, v22, v23
    v_add_f32 v5, v5, v24
    v_add_f32 v6, v6, v25
    v_add_f32 v5, v5, v26
    v_add_f32 v6, v6, v27
    v_add_f32 v9, v5, v6
    s_nop 1
    v_add_f32_dpp v9, v9, v9 row_ror:8 row_mask:0xf bank_mask:0xf
    v_mov_b32 v3, v9
    s_nop 1
    v_permlane16_swap_b32 v9, v3
    v_add_f32 v9, v9, v3
    v_mov_b32 v3, v9
    s_nop 1
    v_permlane32_swap_b32 v9, v3
    v_add_f32 v9, v9, v3
    v_mov_b32 v8, v7
    v_mov_b32 v6, 0
    v_mov_b32 v10, 1
    s_lshl_b32 s50, s48, 3
    v_mov_b32 v11, s50
    s_mov_b64 exec, 1
    ds_write_b64 v11, v[8:9] offset:10624
    ds_add_u32 v6, v10 offset:468
    s_mov_b64 exec, -1
    s_waitcnt vmcnt(2)
    buffer_load_dwordx4 v[44:47], v1, s[8:11], s28 offen offset:3072 nt
    s_branch .Lskip_5
.Lpad_5:
    s_branch .Lbulk2
.Lskip_5:
    s_waitcnt vmcnt(2)
    buffer_load_dwordx4 v[48:51], v1, s[8:11], s28 offen offset:3200 nt
    s_waitcnt vmcnt(2)
    buffer_load_dwordx4 v[52:55], v1, s[8:11], s28 offen offset:3328 nt
    s_waitcnt vmcnt(2)
    buffer_load_dwordx4 v[56:59], v1, s[8:11], s29 offen offset:0 nt
    s_waitcnt vmcnt(2)
    buffer_load_dwordx4 v[60:63], v1, s[8:11], s29 offen offset:128 nt
    s_waitcnt vmcnt(2)
    buffer_load_dwordx4 v[64:67], v1, s[8:11], s29 offen offset:256 nt
    s_waitcnt vmcnt(2)
    buffer_load_dwordx4 v[68:71], v1, s[8:11], s29 offen offset:3072 nt
    s_waitcnt vmcnt(2)
    buffer_load_dwordx4 v[72:75], v1, s[8:11], s29 offen offset:3200 nt
    s_waitcnt vmcnt(2)
    buffer_load_dwordx4 v[76:79], v1, s[8:11], s29 offen offset:3328 nt
    s_mov_b64 exec, 1
    v_mov_b32 v28, 0
    v_mov_b32 v29, 36
    ds_max_u32 v28, v29 offset:448
    s_mov_b64 exec, -1
    s_waitcnt vmcnt(2)
    buffer_load_dwordx4 v[80:83], v1, s[8:11], s30 offen offset:0 nt
    s_waitcnt vmcnt(2)
    buffer_load_dwordx4 v[84:87], v1, s[8:11], s30 offen offset:128 nt
    s_waitcnt vmcnt(2)
    buffer_load_dwordx4 v[88:91], v1, s[8:11], s30 offen offset:256 nt
    s_waitcnt vmcnt(2)
    buffer_load_dwordx4 v[92:95], v1, s[8:11], s30 offen offset:3072 nt
    s_waitcnt vmcnt(2)
    buffer_load_dwordx4 v[96:99], v1, s[8:11], s30 offen offset:3200 nt
    s_waitcnt vmcnt(2)
    buffer_load_dwordx4 v[100:103], v1, s[8:11], s30 offen offset:3328 nt
    s_waitcnt vmcnt(2)
    buffer_load_dwordx4 v[104:107], v1, s[8:11], s31 offen offset:0 nt
    s_waitcnt vmcnt(2)
    buffer_load_dwordx4 v[108:111], v1, s[8:11], s31 offen offset:128 nt
    s_waitcnt vmcnt(2)
    buffer_load_dwordx4 v[112:115], v1, s[8:11], s31 offen offset:256 nt
    s_waitcnt vmcnt(2)
    buffer_load_dwordx4 v[116:119], v1, s[8:11], s31 offen offset:3072 nt
    s_waitcnt vmcnt(2)
    buffer_load_dwordx4 v[120:123], v1, s[8:11], s31 offen offset:3200 nt
    s_waitcnt vmcnt(2)
    buffer_load_dwordx4 v[124:127], v1, s[8:11], s31 offen offset:3328 nt
    s_mov_b64 exec, 1
    v_mov_b32 v28, 0
    v_mov_b32 v29, 1
    ds_add_u32 v28, v29 offset:460
    s_mov_b64 exec, -1
    v_and_b32 v1, 7, v0
    v_lshlrev_b32 v1, 3, v1
    v_bfe_u32 v5, v0, 4, 1
    v_lshl_add_u32 v1, v5, 2, v1
    v_bfe_u32 v5, v0, 3, 1
    v_lshl_add_u32 v1, v5, 1, v1
    v_bfe_u32 v5, v0, 5, 1
    v_add_u32 v1, v5, v1
    s_lshl_b32 s49, s48, 8

    s_mov_b32 s27, 320000
.lw_3:
    ds_read_b32 v3, v6 offset:456
    ds_read_b64 v[4:5], v6 offset:384
    s_waitcnt lgkmcnt(0)
    v_readfirstlane_b32 s40, v3
    s_cmp_ge_u32 s40, 1
    s_cbranch_scc1 .lwd_4
    s_sub_u32 s27, s27, 1
    s_cbranch_scc0 .lw_3
.lwd_4:
    s_mov_b32 s52, s40
    v_sub_f32 v3, v7, v4
    v_mul_f32 v3, 0x3fb8aa3b, v3
    v_exp_f32 v3, v3
    s_nop 0
    v_mul_f32 v7, v3, v5
    v_mul_f32 v3, v20, v7
    v_cvt_pk_bf16_f32 v4, v3, v3
    v_and_b32 v4, v4, v2
    v_cndmask_b32 v28, 0, v4, s[32:33]
    v_cndmask_b32 v29, 0, v4, s[34:35]
    v_cndmask_b32 v30, 0, v4, s[36:37]
    v_cndmask_b32 v31, 0, v4, s[38:39]
    s_nop 1
    v_mfma_f32_16x16x32_bf16 v[8:11], v[28:31], v[32:35], 0
    v_mfma_f32_16x16x32_bf16 v[12:15], v[28:31], v[36:39], 0
    v_mfma_f32_16x16x32_bf16 v[16:19], v[28:31], v[40:43], 0
    v_mul_f32 v3, v21, v7
    v_cvt_pk_bf16_f32 v4, v3, v3
    v_and_b32 v4, v4, v2
    v_cndmask_b32 v28, 0, v4, s[32:33]
    v_cndmask_b32 v29, 0, v4, s[34:35]
    v_cndmask_b32 v30, 0, v4, s[36:37]
    v_cndmask_b32 v31, 0, v4, s[38:39]
    s_nop 1
    v_mfma_f32_16x16x32_bf16 v[8:11], v[28:31], v[44:47], v[8:11]
    v_mfma_f32_16x16x32_bf16 v[12:15], v[28:31], v[48:51], v[12:15]
    v_mfma_f32_16x16x32_bf16 v[16:19], v[28:31], v[52:55], v[16:19]
    v_mul_f32 v3, v22, v7
    v_cvt_pk_bf16_f32 v4, v3, v3
    v_and_b32 v4, v4, v2
    v_cndmask_b32 v28, 0, v4, s[32:33]
    v_cndmask_b32 v29, 0, v4, s[34:35]
    v_cndmask_b32 v30, 0, v4, s[36:37]
    v_cndmask_b32 v31, 0, v4, s[38:39]
    s_nop 1
    v_mfma_f32_16x16x32_bf16 v[8:11], v[28:31], v[56:59], v[8:11]
    v_mfma_f32_16x16x32_bf16 v[12:15], v[28:31], v[60:63], v[12:15]
    v_mfma_f32_16x16x32_bf16 v[16:19], v[28:31], v[64:67], v[16:19]
    v_mul_f32 v3, v23, v7
    v_cvt_pk_bf16_f32 v4, v3, v3
    v_and_b32 v4, v4, v2
    v_cndmask_b32 v28, 0, v4, s[32:33]
    v_cndmask_b32 v29, 0, v4, s[34:35]
    v_cndmask_b32 v30, 0, v4, s[36:37]
    v_cndmask_b32 v31, 0, v4, s[38:39]
    s_nop 1
    v_mfma_f32_16x16x32_bf16 v[8:11], v[28:31], v[68:71], v[8:11]
    v_mfma_f32_16x16x32_bf16 v[12:15], v[28:31], v[72:75], v[12:15]
    v_mfma_f32_16x16x32_bf16 v[16:19], v[28:31], v[76:79], v[16:19]
    v_mul_f32 v3, v24, v7
    v_cvt_pk_bf16_f32 v4, v3, v3
    v_and_b32 v4, v4, v2
    v_cndmask_b32 v28, 0, v4, s[32:33]
    v_cndmask_b32 v29, 0, v4, s[34:35]
    v_cndmask_b32 v30, 0, v4, s[36:37]
    v_cndmask_b32 v31, 0, v4, s[38:39]
    s_nop 1
    v_mfma_f32_16x16x32_bf16 v[8:11], v[28:31], v[80:83], v[8:11]
    v_mfma_f32_16x16x32_bf16 v[12:15], v[28:31], v[84:87], v[12:15]
    v_mfma_f32_16x16x32_bf16 v[16:19], v[28:31], v[88:91], v[16:19]
    v_mul_f32 v3, v25, v7
    v_cvt_pk_bf16_f32 v4, v3, v3
    v_and_b32 v4, v4, v2
    v_cndmask_b32 v28, 0, v4, s[32:33]
    v_cndmask_b32 v29, 0, v4, s[34:35]
    v_cndmask_b32 v30, 0, v4, s[36:37]
    v_cndmask_b32 v31, 0, v4, s[38:39]
    s_nop 1
    v_mfma_f32_16x16x32_bf16 v[8:11], v[28:31], v[92:95], v[8:11]
    v_mfma_f32_16x16x32_bf16 v[12:15], v[28:31], v[96:99], v[12:15]
    v_mfma_f32_16x16x32_bf16 v[16:19], v[28:31], v[100:103], v[16:19]
    v_mul_f32 v3, v26, v7
    v_cvt_pk_bf16_f32 v4, v3, v3
    v_and_b32 v4, v4, v2
    v_cndmask_b32 v28, 0, v4, s[32:33]
    v_cndmask_b32 v29, 0, v4, s[34:35]
    v_cndmask_b32 v30, 0, v4, s[36:37]
    v_cndmask_b32 v31, 0, v4, s[38:39]
    s_nop 1
    v_mfma_f32_16x16x32_bf16 v[8:11], v[28:31], v[104:107], v[8:11]
    v_mfma_f32_16x16x32_bf16 v[12:15], v[28:31], v[108:111], v[12:15]
    v_mfma_f32_16x16x32_bf16 v[16:19], v[28:31], v[112:115], v[16:19]
    v_add_u32 v23, 0, v1
    v_mul_u32_u24 v5, 171, v23
    v_lshrrev_b32 v5, 9, v5
    v_add3_u32 v23, v23, v5, s49
    v_lshlrev_b32 v23, 2, v23
    v_add_u32 v24, 64, v1
    v_mul_u32_u24 v5, 171, v24
    v_lshrrev_b32 v5, 9, v5
    v_add3_u32 v24, v24, v5, s49
    v_lshlrev_b32 v24, 2, v24
    v_add_u32 v25, 128, v1
    v_mul_u32_u24 v5, 171, v25
    v_lshrrev_b32 v5, 9, v5
    v_add3_u32 v25, v25, v5, s49
    v_lshlrev_b32 v25, 2, v25
    v_lshlrev_b32 v6, 4, v0
    v_lshlrev_b32 v5, 7, v0
    s_lshl_b32 s50, s24, 13
    s_lshl_b32 s51, s25, 4
    s_add_u32 s50, s50, s51
    s_add_u32 s50, s50, 1048576
    v_mul_f32 v3, v27, v7
    v_cvt_pk_bf16_f32 v4, v3, v3
    v_and_b32 v4, v4, v2
    v_cndmask_b32 v28, 0, v4, s[32:33]
    v_cndmask_b32 v29, 0, v4, s[34:35]
    v_cndmask_b32 v30, 0, v4, s[36:37]
    v_cndmask_b32 v31, 0, v4, s[38:39]
    s_waitcnt vmcnt(2)
    s_nop 0
    v_mfma_f32_16x16x32_bf16 v[8:11], v[28:31], v[116:119], v[8:11]
    s_waitcnt vmcnt(1)
    v_mfma_f32_16x16x32_bf16 v[12:15], v[28:31], v[120:123], v[12:15]
    s_waitcnt vmcnt(0)
    v_mfma_f32_16x16x32_bf16 v[16:19], v[28:31], v[124:127], v[16:19]
    s_nop 3
    v_permlane32_swap_b32 v8, v9
    v_permlane32_swap_b32 v10, v11
    s_nop 0
    v_add_f32_dpp v20, v9, v8 row_ror:8 row_mask:0xf bank_mask:0x3
    s_nop 1
    v_add_f32_dpp v20, v10, v11 row_ror:8 row_mask:0xf bank_mask:0xc
    v_permlane32_swap_b32 v12, v13
    v_permlane32_swap_b32 v14, v15
    s_nop 0
    v_add_f32_dpp v21, v13, v12 row_ror:8 row_mask:0xf bank_mask:0x3
    s_nop 1
    v_add_f32_dpp v21, v14, v15 row_ror:8 row_mask:0xf bank_mask:0xc
    v_permlane32_swap_b32 v16, v17
    v_permlane32_swap_b32 v18, v19
    s_nop 0
    v_add_f32_dpp v22, v17, v16 row_ror:8 row_mask:0xf bank_mask:0x3
    s_nop 1
    v_add_f32_dpp v22, v18, v19 row_ror:8 row_mask:0xf bank_mask:0xc
    ds_write_b32 v23, v20 offset:512
    ds_write_b32 v24, v21 offset:512
    s_branch .Lskip_6
.Lpad_6:
    s_branch .Lbulk2
.Lskip_6:
    ds_write_b32 v25, v22 offset:512
    v_mov_b32 v11, s26
    s_waitcnt lgkmcnt(0)
    s_barrier
    s_cmp_ge_u32 s48, 1
    s_cbranch_scc1 .Lbulk_opub
    ds_read_b128 v[32:35], v6 offset:512
    ds_read_b128 v[36:39], v6 offset:1536
    ds_read_b128 v[40:43], v6 offset:2560
    ds_read_b128 v[44:47], v6 offset:3584
    ds_read_b128 v[48:51], v6 offset:4608
    ds_read_b128 v[52:55], v6 offset:5632
    ds_read_b128 v[56:59], v6 offset:6656
    ds_read_b128 v[60:63], v6 offset:7680
    s_waitcnt lgkmcnt(6)
    v_pk_add_f32 v[32:33], v[32:33], v[36:37]
    v_add_f32 v34, v34, v38
    s_waitcnt lgkmcnt(4)
    v_pk_add_f32 v[40:41], v[40:41], v[44:45]
    v_add_f32 v42, v42, v46
    s_waitcnt lgkmcnt(2)
    v_pk_add_f32 v[48:49], v[48:49], v[52:53]
    v_add_f32 v50, v50, v54
    s_waitcnt lgkmcnt(0)
    v_pk_add_f32 v[56:57], v[56:57], v[60:61]
    v_add_f32 v58, v58, v62
    v_pk_add_f32 v[32:33], v[32:33], v[40:41]
    v_add_f32 v34, v34, v42
    v_pk_add_f32 v[48:49], v[48:49], v[56:57]
    v_add_f32 v50, v50, v58
    v_pk_add_f32 v[8:9], v[32:33], v[48:49]
    v_add_f32 v10, v34, v50
    s_cmp_eq_u32 s52, 1
    s_cbranch_scc0 .Lbulk_opy
    buffer_store_dwordx4 v[8:11], v5, s[12:15], s50 offen
    s_branch .Lbulk_opub
.Lbulk_opy:
    buffer_store_dwordx4 v[8:11], v5, s[12:15], s50 offen sc1
.Lbulk_opub:
    s_lshl_b32 s60, s24, 3
    s_or_b32 s60, s60, s25
    s_cmp_ge_u32 s60, 80
    s_cbranch_scc1 .Lbulk_end
    v_and_b32 v31, 3, v0
    v_lshlrev_b32 v31, 4, v31
    s_lshr_b32 s49, s60, 3
    s_lshl_b32 s49, s49, 7
    s_and_b32 s50, s60, 1
    s_lshl_b32 s50, s50, 6
    s_add_u32 s49, s49, s50
    s_and_b32 s50, s60, 6
    s_lshl_b32 s50, s50, 1
    s_add_u32 s49, s49, s50
    buffer_load_dword v30, v31, s[16:19], s49 offen

    v_lshlrev_b32 v1, 4, v0
    s_mul_i32 s50, s60, 17664
    s_lshl_b32 s51, s48, 11
    s_add_u32 s50, s50, s51
    s_add_u32 s50, s50, 2097152
    v_lshlrev_b32 v3, 3, v0
    s_lshl_b32 s51, s48, 5
    v_add_u32 v3, s51, v3
    s_mul_i32 s51, s60, 5376
    s_lshl_b32 s52, s48, 9
    s_add_u32 s51, s51, s52
    s_add_u32 s51, s51, 1572864
    v_mov_b32 v8, 0
    v_mov_b32 v9, 0
    v_mov_b32 v12, 0
    v_mov_b32 v13, 0
    s_mov_b64 s[44:45], -1
    s_mov_b64 s[46:47], -1
    s_mov_b32 s52, -1
    s_mov_b32 s53, 0
    s_barrier
    s_mov_b32 s27, 40000
.Lag_1:
    s_or_b64 exec, s[52:53], 1
    buffer_load_dwordx4 v[32:35], v1, s[12:15], s51 offen sc1
    s_or_b64 exec, s[44:45], 1
    buffer_load_dwordx4 v[36:39], v1, s[12:15], s50 offen sc1
    s_or_b64 exec, s[46:47], 1
    buffer_load_dwordx4 v[40:43], v1, s[12:15], s50 offen offset:1024 sc1
    s_mov_b64 exec, s[52:53]
    s_waitcnt vmcnt(2)
    v_cmp_eq_u32 vcc, s26, v33
    v_cmp_eq_u32 s[42:43], s26, v35
    s_and_b64 exec, vcc, s[42:43]
    v_add_f32 v12, v12, v32
    v_add_f32 v13, v13, v34
    s_andn2_b64 s[52:53], s[52:53], exec
    s_mov_b64 exec, s[44:45]
    s_waitcnt vmcnt(1)
    v_cmp_eq_u32 vcc, s26, v37
    v_cmp_eq_u32 s[42:43], s26, v39
    s_and_b64 exec, vcc, s[42:43]
    v_add_f32 v8, v8, v36
    v_add_f32 v9, v9, v38
    s_andn2_b64 s[44:45], s[44:45], exec
    s_mov_b64 exec, s[46:47]
    s_waitcnt vmcnt(0)
    v_cmp_eq_u32 vcc, s26, v41
    v_cmp_eq_u32 s[42:43], s26, v43
    s_and_b64 exec, vcc, s[42:43]
    v_add_f32 v8, v8, v40
    v_add_f32 v9, v9, v42
    s_andn2_b64 s[46:47], s[46:47], exec
    s_or_b64 s[40:41], s[44:45], s[46:47]
    s_or_b64 s[40:41], s[40:41], s[52:53]
    s_cbranch_scc0 .Lag_done
.Lag_0:
    s_bcnt1_i32_b64 s40, s[44:45]
    s_bcnt1_i32_b64 s41, s[46:47]
    s_add_u32 s40, s40, s41
    s_cmp_le_u32 s40, 32
    s_cbranch_scc1 .Lag_2
    s_sub_u32 s27, s27, 1
    s_cbranch_scc0 .Lag_1
    s_branch .Lag_fail
.Lag_2:
    s_or_b64 exec, s[52:53], 1
    buffer_load_dwordx4 v[32:35], v1, s[12:15], s51 offen sc1
    s_or_b64 exec, s[44:45], 1
    buffer_load_dwordx4 v[36:39], v1, s[12:15], s50 offen sc1
    s_or_b64 exec, s[46:47], 1
    buffer_load_dwordx4 v[40:43], v1, s[12:15], s50 offen offset:1024 sc1
    s_or_b64 exec, s[52:53], 1
    buffer_load_dwordx4 v[44:47], v1, s[12:15], s51 offen sc1
    s_or_b64 exec, s[44:45], 1
    buffer_load_dwordx4 v[48:51], v1, s[12:15], s50 offen sc1
    s_or_b64 exec, s[46:47], 1
    buffer_load_dwordx4 v[52:55], v1, s[12:15], s50 offen offset:1024 sc1
    s_or_b64 exec, s[52:53], 1
    buffer_load_dwordx4 v[56:59], v1, s[12:15], s51 offen sc1
    s_or_b64 exec, s[44:45], 1
    buffer_load_dwordx4 v[60:63], v1, s[12:15], s50 offen sc1
    s_or_b64 exec, s[46:47], 1
    buffer_load_dwordx4 v[64:67], v1, s[12:15], s50 offen offset:1024 sc1
.Lag_3:
    s_or_b64 exec, s[52:53], 1
    buffer_load_dwordx4 v[68:71], v1, s[12:15], s51 offen sc1
    s_or_b64 exec, s[44:45], 1
    buffer_load_dwordx4 v[72:75], v1, s[12:15], s50 offen sc1
    s_or_b64 exec, s[46:47], 1
    buffer_load_dwordx4 v[76:79], v1, s[12:15], s50 offen offset:1024 sc1
    s_mov_b64 exec, s[52:53]
    s_waitcnt vmcnt(11)
    v_cmp_eq_u32 vcc, s26, v33
    v_cmp_eq_u32 s[42:43], s26, v35
    s_and_b64 exec, vcc, s[42:43]
    v_add_f32 v12, v12, v32
    v_add_f32 v13, v13, v34
    s_andn2_b64 s[52:53], s[52:53], exec
    s_mov_b64 exec, s[44:45]
    s_waitcnt vmcnt(10)
    v_cmp_eq_u32 vcc, s26, v37
    v_cmp_eq_u32 s[42:43], s26, v39
    s_and_b64 exec, vcc, s[42:43]
    v_add_f32 v8, v8, v36
    v_add_f32 v9, v9, v38
    s_andn2_b64 s[44:45], s[44:45], exec
    s_mov_b64 exec, s[46:47]
    s_waitcnt vmcnt(9)
    v_cmp_eq_u32 vcc, s26, v41
    v_cmp_eq_u32 s[42:43], s26, v43
    s_and_b64 exec, vcc, s[42:43]
    v_add_f32 v8, v8, v40
    v_add_f32 v9, v9, v42
    s_andn2_b64 s[46:47], s[46:47], exec
    s_or_b64 s[40:41], s[44:45], s[46:47]
    s_or_b64 s[40:41], s[40:41], s[52:53]
    s_cbranch_scc0 .Lag_done
    s_or_b64 exec, s[52:53], 1
    buffer_load_dwordx4 v[32:35], v1, s[12:15], s51 offen sc1
    s_or_b64 exec, s[44:45], 1
    buffer_load_dwordx4 v[36:39], v1, s[12:15], s50 offen sc1
    s_or_b64 exec, s[46:47], 1
    buffer_load_dwordx4 v[40:43], v1, s[12:15], s50 offen offset:1024 sc1
    s_mov_b64 exec, s[52:53]
    s_waitcnt vmcnt(11)
    v_cmp_eq_u32 vcc, s26, v45
    v_cmp_eq_u32 s[42:43], s26, v47
    s_and_b64 exec, vcc, s[42:43]
    v_add_f32 v12, v12, v44
    v_add_f32 v13, v13, v46
    s_andn2_b64 s[52:53], s[52:53], exec
    s_mov_b64 exec, s[44:45]
    s_waitcnt vmcnt(10)
    v_cmp_eq_u32 vcc, s26, v49
    v_cmp_eq_u32 s[42:43], s26, v51
    s_and_b64 exec, vcc, s[42:43]
    v_add_f32 v8, v8, v48
    v_add_f32 v9, v9, v50
    s_andn2_b64 s[44:45], s[44:45], exec
    s_mov_b64 exec, s[46:47]
    s_waitcnt vmcnt(9)
    v_cmp_eq_u32 vcc, s26, v53
    v_cmp_eq_u32 s[42:43], s26, v55
    s_and_b64 exec, vcc, s[42:43]
    v_add_f32 v8, v8, v52
    v_add_f32 v9, v9, v54
    s_andn2_b64 s[46:47], s[46:47], exec
    s_or_b64 s[40:41], s[44:45], s[46:47]
    s_or_b64 s[40:41], s[40:41], s[52:53]
    s_cbranch_scc0 .Lag_done
    s_or_b64 exec, s[52:53], 1
    buffer_load_dwordx4 v[44:47], v1, s[12:15], s51 offen sc1
    s_or_b64 exec, s[44:45], 1
    buffer_load_dwordx4 v[48:51], v1, s[12:15], s50 offen sc1
    s_or_b64 exec, s[46:47], 1
    buffer_load_dwordx4 v[52:55], v1, s[12:15], s50 offen offset:1024 sc1
    s_mov_b64 exec, s[52:53]
    s_waitcnt vmcnt(11)
    v_cmp_eq_u32 vcc, s26, v57
    v_cmp_eq_u32 s[42:43], s26, v59
    s_and_b64 exec, vcc, s[42:43]
    v_add_f32 v12, v12, v56
    v_add_f32 v13, v13, v58
    s_andn2_b64 s[52:53], s[52:53], exec
    s_mov_b64 exec, s[44:45]
    s_waitcnt vmcnt(10)
    v_cmp_eq_u32 vcc, s26, v61
    v_cmp_eq_u32 s[42:43], s26, v63
    s_and_b64 exec, vcc, s[42:43]
    v_add_f32 v8, v8, v60
    v_add_f32 v9, v9, v62
    s_andn2_b64 s[44:45], s[44:45], exec
    s_mov_b64 exec, s[46:47]
    s_waitcnt vmcnt(9)
    v_cmp_eq_u32 vcc, s26, v65
    v_cmp_eq_u32 s[42:43], s26, v67
    s_and_b64 exec, vcc, s[42:43]
    v_add_f32 v8, v8, v64
    v_add_f32 v9, v9, v66
    s_andn2_b64 s[46:47], s[46:47], exec
    s_or_b64 s[40:41], s[44:45], s[46:47]
    s_or_b64 s[40:41], s[40:41], s[52:53]
    s_cbranch_scc0 .Lag_done
    s_or_b64 exec, s[52:53], 1
    buffer_load_dwordx4 v[56:59], v1, s[12:15], s51 offen sc1
    s_or_b64 exec, s[44:45], 1
    buffer_load_dwordx4 v[60:63], v1, s[12:15], s50 offen sc1
    s_or_b64 exec, s[46:47], 1
    buffer_load_dwordx4 v[64:67], v1, s[12:15], s50 offen offset:1024 sc1
    s_mov_b64 exec, s[52:53]
    s_waitcnt vmcnt(11)
    v_cmp_eq_u32 vcc, s26, v69
    v_cmp_eq_u32 s[42:43], s26, v71
    s_and_b64 exec, vcc, s[42:43]
    v_add_f32 v12, v12, v68
    v_add_f32 v13, v13, v70
    s_andn2_b64 s[52:53], s[52:53], exec
    s_mov_b64 exec, s[44:45]
    s_waitcnt vmcnt(10)
    v_cmp_eq_u32 vcc, s26, v73
    v_cmp_eq_u32 s[42:43], s26, v75
    s_and_b64 exec, vcc, s[42:43]
    v_add_f32 v8, v8, v72
    v_add_f32 v9, v9, v74
    s_andn2_b64 s[44:45], s[44:45], exec
    s_mov_b64 exec, s[46:47]
    s_branch .Lskip_7
.Lpad_7:
    s_branch .Lbulk2
.Lskip_7:
    s_waitcnt vmcnt(9)
    v_cmp_eq_u32 vcc, s26, v77
    v_cmp_eq_u32 s[42:43], s26, v79
    s_and_b64 exec, vcc, s[42:43]
    v_add_f32 v8, v8, v76
    v_add_f32 v9, v9, v78
    s_andn2_b64 s[46:47], s[46:47], exec
    s_or_b64 s[40:41], s[44:45], s[46:47]
    s_or_b64 s[40:41], s[40:41], s[52:53]
    s_cbranch_scc0 .Lag_done
    s_sub_u32 s27, s27, 1
    s_cbranch_scc0 .Lag_3
.Lag_fail:
.Lag_done:
    s_mov_b64 exec, -1
    v_add_f32_dpp v8, v8, v8 row_ror:4 row_mask:0xf bank_mask:0xf
    v_add_f32_dpp v9, v9, v9 row_ror:4 row_mask:0xf bank_mask:0xf
    v_add_f32_dpp v12, v12, v12 row_ror:4 row_mask:0xf bank_mask:0xf
    v_add_f32_dpp v13, v13, v13 row_ror:4 row_mask:0xf bank_mask:0xf
    v_add_f32_dpp v8, v8, v8 row_ror:8 row_mask:0xf bank_mask:0xf
    v_add_f32_dpp v9, v9, v9 row_ror:8 row_mask:0xf bank_mask:0xf
    v_add_f32_dpp v12, v12, v12 row_ror:8 row_mask:0xf bank_mask:0xf
    v_add_f32_dpp v13, v13, v13 row_ror:8 row_mask:0xf bank_mask:0xf
    v_mov_b32 v10, v8
    v_mov_b32 v11, v9
    v_mov_b32 v14, v12
    v_mov_b32 v15, v13
    v_permlane16_swap_b32 v8, v10
    v_permlane16_swap_b32 v9, v11
    v_permlane16_swap_b32 v12, v14
    v_permlane16_swap_b32 v13, v15
    v_add_f32 v8, v8, v10
    v_add_f32 v9, v9, v11
    v_add_f32 v12, v12, v14
    v_add_f32 v13, v13, v15
    v_mov_b32 v10, v8
    v_mov_b32 v11, v9
    v_mov_b32 v14, v12
    v_mov_b32 v15, v13
    v_permlane32_swap_b32 v8, v10
    v_permlane32_swap_b32 v9, v11
    v_permlane32_swap_b32 v12, v14
    v_permlane32_swap_b32 v13, v15
    v_add_f32 v8, v8, v10
    v_add_f32 v9, v9, v11
    v_add_f32 v12, v12, v14
    v_add_f32 v13, v13, v15
    s_mov_b64 exec, 15
    ds_write_b64 v3, v[8:9] offset:8704
    ds_write_b64 v3, v[12:13] offset:8960
    s_mov_b64 exec, -1
    s_waitcnt lgkmcnt(0)
    s_barrier
    s_cmp_lg_u32 s48, 0
    s_cbranch_scc1 .Lbulk_end
    v_lshlrev_b32 v3, 3, v0
    ds_read_b64 v[8:9], v3 offset:8704
    v_lshlrev_b32 v14, 16, v30
    v_and_b32 v15, 0xffff0000, v30
    s_waitcnt lgkmcnt(0)
    v_add_f32_dpp v8, v8, v8 row_ror:4 row_mask:0xf bank_mask:0xf
    v_add_f32_dpp v9, v9, v9 row_ror:4 row_mask:0xf bank_mask:0xf
    s_nop 0
    v_add_f32_dpp v8, v8, v8 row_ror:8 row_mask:0xf bank_mask:0xf
    v_add_f32_dpp v9, v9, v9 row_ror:8 row_mask:0xf bank_mask:0xf
    v_mov_b32 v10, v8
    v_mov_b32 v11, v9
    s_nop 0
    v_permlane16_swap_b32 v8, v10
    v_permlane16_swap_b32 v9, v11
    v_add_f32 v8, v8, v10
    v_add_f32 v9, v9, v11
    v_cvt_pk_bf16_f32 v8, v8, v9
    v_mov_b32 v12, v8
    s_nop 1
    v_permlane32_swap_b32 v8, v12
    v_and_b32 v9, 0xffff0000, v8
    v_lshlrev_b32 v8, 16, v8
    v_add_f32 v8, v8, v14
    v_add_f32 v9, v9, v15
    v_and_b32 v13, 0xffff0000, v12
    v_lshlrev_b32 v12, 16, v12
    v_cvt_pk_bf16_f32 v8, v8, v9
    v_and_b32 v9, 0xffff0000, v8
    v_lshlrev_b32 v8, 16, v8
    v_add_f32 v8, v8, v12
    v_add_f32 v9, v9, v13
    v_cvt_pk_bf16_f32 v8, v8, v9
    s_mov_b64 exec, 15
    buffer_store_dword v8, v31, s[20:23], s49 offen
    s_cmp_lg_u32 s60, 0
    s_cbranch_scc1 .Lbulk_end
    s_mov_b64 exec, 1
    v_mov_b32 v9, s26
    v_mov_b32 v1, 0
    buffer_store_dword v9, v1, s[12:15], 0 offen
.Lbulk_end:
    s_endpgm
.section .rodata,"a"
.p2align 6
.amdhsa_kernel parallel_sum__mha_block_cached__glu_gated_glu__decode_kernel
  .amdhsa_next_free_vgpr 128
  .amdhsa_next_free_sgpr 102
  .amdhsa_accum_offset 128
  .amdhsa_group_segment_fixed_size 0
  .amdhsa_kernarg_size 96
  .amdhsa_user_sgpr_count 2
  .amdhsa_user_sgpr_kernarg_segment_ptr 1
  .amdhsa_system_sgpr_workgroup_id_x 1
.end_amdhsa_kernel
```
